```python
import torch

def _softmax(x, axis=-1):
    return torch.softmax(x, dim=axis)
def _gelu(x):
    return torch.nn.functional.gelu(x, approximate="tanh")
def _silu(x):
    return torch.nn.functional.silu(x)
def _sigmoid(x):
    return torch.sigmoid(x)
def _layernorm(x, axis=-1, eps=1e-5):
    m = x.mean(dim=axis, keepdim=True)
    v = x.var(dim=axis, keepdim=True, unbiased=False)
    return (x - m) / torch.sqrt(v + eps)
def _scatter_add(tgt, idx, src, axis=0):
    return tgt.clone().index_add_(axis, idx, src)
def _segment_sum(src, seg, n):
    out = torch.zeros((n,) + src.shape[1:], dtype=src.dtype)
    return out.index_add_(0, seg, src)
def _pad(x, pw):
    flat = tuple(v for pair in reversed(pw) for v in pair)
    return torch.nn.functional.pad(x, flat)

kernel_name = 'sequential_preLN__gqa_block_cached__mixer_token_mlp__decode'

def setup_inputs():

    _w = (lambda a: (lambda t: t.to(torch.bfloat16) if t.is_floating_point() else t)(torch.as_tensor(a)))
    def _A_setup():
        B, Sq, D = 1, 1, 512
        Hq, Hkv, Sk, Dh = 32, 8, 65536, 128
        assert Hq % Hkv == 0, (Hq, Hkv)
        return {
            "x": _w((lambda *s: torch.randn(*s, dtype=torch.bfloat16) * 0.1)(B, Sq, D)),
            "k_cache": _w((lambda *s: torch.randn(*s, dtype=torch.bfloat16) * 1.6)(B, Hkv, Sk, Dh)),
            "v_cache": _w((lambda *s: torch.randn(*s, dtype=torch.bfloat16) * 1.6)(B, Hkv, Sk, Dh)),
            "wq": _w((lambda *s: torch.randn(*s, dtype=torch.bfloat16) * 1.6)(D, Hq * Dh) * (D ** -0.5)),
            "wo": _w((lambda *s: torch.randn(*s, dtype=torch.bfloat16) * 1.6)(Hq * Dh, D) * ((Hq * Dh) ** -0.5)),
        }
    _A_in = _A_setup()

    def _B_setup():
        B, S, D, F = 1, 1, 512, 1792
        return {
            "x": _w((lambda *s: torch.randn(*s, dtype=torch.bfloat16) * 0.1)(B, S, D)),
            "w1": _w((lambda *s: torch.randn(*s, dtype=torch.bfloat16) * 1.6)(S, F) * (S ** -0.5)),
            "b1": _w((lambda *s: torch.randn(*s, dtype=torch.bfloat16) * 1.6)(F) * 0.02),
            "w2": _w((lambda *s: torch.randn(*s, dtype=torch.bfloat16) * 1.6)(F, S) * (F ** -0.5)),
            "b2": _w((lambda *s: torch.randn(*s, dtype=torch.bfloat16) * 1.6)(S) * 0.02),
        }
    _B_in = _B_setup()

    return {
        "A_x": _A_in["x"],
        "A_k_cache": _A_in["k_cache"],
        "A_v_cache": _A_in["v_cache"],
        "A_wq": _A_in["wq"],
        "A_wo": _A_in["wo"],
        "B_x": _B_in["x"],
        "B_w1": _B_in["w1"],
        "B_b1": _B_in["b1"],
        "B_w2": _B_in["w2"],
        "B_b2": _B_in["b2"],
    }

def reference(A_x, A_k_cache, A_v_cache, A_wq, A_wo, B_x, B_w1, B_b1, B_w2, B_b2):
    def _A_ref(x, k_cache, v_cache, wq, wo):
        B, Sq, D = x.shape
        Hq, Dh = 32, 128
        Hkv = k_cache.shape[1]
        rep = Hq // Hkv
        q = (lambda x, *d: x.permute(*d))((x @ wq).reshape(B, Sq, Hq, Dh), 0, 2, 1, 3)
        k = (lambda x, n, axis: torch.repeat_interleave(x, n, dim=axis))(k_cache, rep, axis=1)
        v = (lambda x, n, axis: torch.repeat_interleave(x, n, dim=axis))(v_cache, rep, axis=1)
        scores = torch.einsum("bhqd,bhkd->bhqk", q, k) * (Dh ** -0.5)
        p = _softmax(scores, axis=-1)
        o = torch.einsum("bhqk,bhkd->bhqd", p, v)
        return (lambda x, *d: x.permute(*d))(o, 0, 2, 1, 3).reshape(B, Sq, Hq * Dh) @ wo

    def _B_ref(x, w1, b1, w2, b2):
        B, S, D = x.shape
        h = _layernorm(x, axis=-1)
        u = torch.einsum("bsd,sf->bdf", h, w1) + b1
        u = _gelu(u)
        y = torch.einsum("bdf,fs->bds", u, w2) + b2
        return (lambda x, *d: x.permute(*d))(y, 0, 2, 1)

    x = A_x
    h = x + _A_ref(_layernorm(x, axis=-1), A_k_cache, A_v_cache, A_wq, A_wo)
    h2 = h + _B_ref(_layernorm(h, axis=-1), B_w1, B_b1, B_w2, B_b2)
    return h2
```

```asm
; @launch grid=(256,1,1) block=(512,1,1) lds=147200
.amdgcn_target "amdgcn-amd-amdhsa--gfx950"
.text
.globl sequential_preLN__gqa_block_cached__mixer_token_mlp__decode_kernel
.p2align 8
.type sequential_preLN__gqa_block_cached__mixer_token_mlp__decode_kernel,@function
sequential_preLN__gqa_block_cached__mixer_token_mlp__decode_kernel:
  s_cmp_ge_u32 s2, 256
  s_cbranch_scc1 sequential_preLN__gqa_block_cached__mixer_token_mlp__decode_kernel_end
  s_load_dwordx8 s[36:43], s[0:1], 0
  s_load_dwordx2 s[46:47], s[0:1], 96
  v_lshrrev_b32 v1, 6, v0
  s_nop 0
  v_readfirstlane_b32 s3, v1
  v_and_b32 v0, 63, v0
  s_and_b32 s20, s2, 7
  s_lshr_b32 s21, s2, 3
  s_cmp_eq_u32 s3, 0
  s_cbranch_scc1 sequential_preLN__gqa_block_cached__mixer_token_mlp__decode_kernel_w0
  s_mov_b32 s22, 57344
  s_lshl_b32 s29, s3, 13
  v_and_b32 v1, 3, v0
  v_lshlrev_b32 v1, 10, v1
  v_bfe_u32 v11, v0, 2, 2
  v_lshl_add_u32 v1, v11, 8, v1
  v_lshrrev_b32 v11, 4, v0
  v_lshl_add_u32 v1, v11, 4, v1
  v_add_u32 v1, s29, v1
  v_add_u32 v2, 0x1000, v1
  v_lshlrev_b32 v3, 4, v0
  v_add_u32 v3, s29, v3
  v_add_u32 v4, 0x1000, v3
  s_lshl_b32 s29, s20, 24
  s_xor_b32 s30, s21, 0
  s_lshl_b32 s30, s30, 19
  s_add_u32 s29, s29, s30
  s_mov_b32 s10, 0x80000
  s_mov_b32 s11, 0x20000
  s_mov_b32 s14, 0x80000
  s_mov_b32 s15, 0x20000
  s_waitcnt lgkmcnt(0)
  s_add_u32 s8, s38, s29
  s_addc_u32 s9, s39, 0
  s_add_u32 s12, s40, s29
  s_addc_u32 s13, s41, 0
  buffer_load_dwordx4 v[112:115], v1, s[8:11], 0 offen offset:0 nt
  buffer_load_dwordx4 v[116:119], v1, s[8:11], 0 offen offset:64 nt
  buffer_load_dwordx4 v[120:123], v1, s[8:11], 0 offen offset:128 nt
  buffer_load_dwordx4 v[124:127], v1, s[8:11], 0 offen offset:192 nt
  s_load_dwordx2 s[48:49], s[0:1], 32
  s_load_dwordx8 s[52:59], s[0:1], 48
  s_load_dwordx2 s[50:51], s[0:1], 80
  s_load_dword s61, s[46:47], 0
  s_getreg_b32 s63, hwreg(HW_REG_XCC_ID, 0, 4)
  s_mov_b32 s25, 0x05040100
  s_mov_b32 s26, 0x07060302
  s_mov_b32 s27, 0x3fb8aa3b
  s_mov_b32 s28, 0x3db504f3
  s_barrier
  buffer_load_dwordx4 v[128:131], v2, s[8:11], 0 offen offset:0 nt
  buffer_load_dwordx4 v[132:135], v2, s[8:11], 0 offen offset:64 nt
  buffer_load_dwordx4 v[136:139], v2, s[8:11], 0 offen offset:128 nt
  buffer_load_dwordx4 v[140:143], v2, s[8:11], 0 offen offset:192 nt
  v_add_u32 v1, s22, v1
  v_add_u32 v2, s22, v2
  buffer_load_dwordx4 v[144:147], v3, s[12:15], 0 offen offset:0 nt
  buffer_load_dwordx4 v[148:151], v3, s[12:15], 0 offen offset:1024 nt
  buffer_load_dwordx4 v[152:155], v3, s[12:15], 0 offen offset:2048 nt
  buffer_load_dwordx4 v[156:159], v3, s[12:15], 0 offen offset:3072 nt
  buffer_load_dwordx4 v[160:163], v4, s[12:15], 0 offen offset:0 nt
  buffer_load_dwordx4 v[164:167], v4, s[12:15], 0 offen offset:1024 nt
  buffer_load_dwordx4 v[168:171], v4, s[12:15], 0 offen offset:2048 nt
  buffer_load_dwordx4 v[172:175], v4, s[12:15], 0 offen offset:3072 nt
  v_add_u32 v3, s22, v3
  v_add_u32 v4, s22, v4
  buffer_load_dwordx4 v[176:179], v1, s[8:11], 0 offen offset:0 nt
  buffer_load_dwordx4 v[180:183], v1, s[8:11], 0 offen offset:64 nt
  buffer_load_dwordx4 v[184:187], v1, s[8:11], 0 offen offset:128 nt
  buffer_load_dwordx4 v[188:191], v1, s[8:11], 0 offen offset:192 nt
  buffer_load_dwordx4 v[192:195], v2, s[8:11], 0 offen offset:0 nt
  buffer_load_dwordx4 v[196:199], v2, s[8:11], 0 offen offset:64 nt
  buffer_load_dwordx4 v[200:203], v2, s[8:11], 0 offen offset:128 nt
  buffer_load_dwordx4 v[204:207], v2, s[8:11], 0 offen offset:192 nt
  v_add_u32 v1, s22, v1
  v_add_u32 v2, s22, v2
  buffer_load_dwordx4 v[208:211], v3, s[12:15], 0 offen offset:0 nt
  buffer_load_dwordx4 v[212:215], v3, s[12:15], 0 offen offset:1024 nt
  buffer_load_dwordx4 v[216:219], v3, s[12:15], 0 offen offset:2048 nt
  buffer_load_dwordx4 v[220:223], v3, s[12:15], 0 offen offset:3072 nt
  buffer_load_dwordx4 v[224:227], v4, s[12:15], 0 offen offset:0 nt
  buffer_load_dwordx4 v[228:231], v4, s[12:15], 0 offen offset:1024 nt
  buffer_load_dwordx4 v[232:235], v4, s[12:15], 0 offen offset:2048 nt
  buffer_load_dwordx4 v[236:239], v4, s[12:15], 0 offen offset:3072 nt
  v_add_u32 v3, s22, v3
  v_add_u32 v4, s22, v4
  s_lshl_b32 s24, s3, 14
  s_add_u32 s24, s24, 16128
  s_add_u32 m0, s24, 0
  s_nop 0
  buffer_load_dwordx4 v1, s[8:11], 0 offen offset:0 nt lds
  s_add_u32 m0, s24, 960
  s_nop 0
  buffer_load_dwordx4 v1, s[8:11], 0 offen offset:64 nt lds
  s_add_u32 m0, s24, 1920
  s_nop 0
  buffer_load_dwordx4 v1, s[8:11], 0 offen offset:128 nt lds
  s_add_u32 m0, s24, 2880
  s_nop 0
  buffer_load_dwordx4 v1, s[8:11], 0 offen offset:192 nt lds
  s_add_u32 m0, s24, 4096
  s_nop 0
  buffer_load_dwordx4 v2, s[8:11], 0 offen offset:0 nt lds
  s_add_u32 m0, s24, 5056
  s_nop 0
  buffer_load_dwordx4 v2, s[8:11], 0 offen offset:64 nt lds
  s_add_u32 m0, s24, 6016
  s_nop 0
  buffer_load_dwordx4 v2, s[8:11], 0 offen offset:128 nt lds
  s_add_u32 m0, s24, 6976
  s_nop 0
  buffer_load_dwordx4 v2, s[8:11], 0 offen offset:192 nt lds
  v_add_u32 v1, s22, v1
  v_add_u32 v2, s22, v2
  s_add_u32 m0, s24, 8192
  s_nop 0
  buffer_load_dwordx4 v3, s[12:15], 0 offen offset:0 nt lds
  buffer_load_dwordx4 v3, s[12:15], 0 offen offset:1024 nt lds
  buffer_load_dwordx4 v3, s[12:15], 0 offen offset:2048 nt lds
  buffer_load_dwordx4 v3, s[12:15], 0 offen offset:3072 nt lds
  s_add_u32 m0, s24, 12288
  s_nop 0
  buffer_load_dwordx4 v4, s[12:15], 0 offen offset:0 nt lds
  buffer_load_dwordx4 v4, s[12:15], 0 offen offset:1024 nt lds
  buffer_load_dwordx4 v4, s[12:15], 0 offen offset:2048 nt lds
  buffer_load_dwordx4 v4, s[12:15], 0 offen offset:3072 nt lds
  v_add_u32 v3, s22, v3
  v_add_u32 v4, s22, v4
  s_lshl_b32 s29, s20, 19
  s_and_b32 s30, s21, 1
  s_lshl_b32 s30, s30, 18
  s_add_u32 s29, s29, s30
  s_lshl_b32 s30, s3, 10
  s_add_u32 s29, s29, s30
  s_lshr_b32 s30, s21, 1
  s_lshl_b32 s30, s30, 6
  s_add_u32 s29, s29, s30
  v_lshrrev_b32 v24, 2, v0
  v_lshlrev_b32 v24, 13, v24
  v_and_b32 v25, 3, v0
  v_lshl_add_u32 v24, v25, 4, v24
  v_add_u32 v24, s29, v24
  v_add_u32 v25, 0x20000, v24
  s_waitcnt lgkmcnt(0)
  global_load_dwordx4 v[240:243], v24, s[48:49] nt
  global_load_dwordx4 v[244:247], v25, s[48:49] nt
  s_lshl_b32 s29, s3, 8
  v_lshl_add_u32 v24, v0, 2, s29
  v_add_u32 v25, 2048, v24
  v_min_u32 v25, 3580, v25
  v_lshrrev_b32 v26, 1, v24
  global_load_dword v248, v24, s[52:53]
  global_load_dword v249, v25, s[52:53]
  global_load_dword v250, v24, s[54:55]
  global_load_dword v251, v25, s[54:55]
  global_load_dword v252, v24, s[56:57]
  global_load_dword v253, v25, s[56:57]
  global_load_ushort v254, v26, s[36:37]
  global_load_ushort v255, v26, s[50:51]
  v_mov_b32 v5, 0xff800000
  v_mov_b32 v7, 0
  v_mov_b32 v6, 0
  v_mov_b32 v44, 0
  v_mov_b32 v45, 0
  v_mov_b32 v46, 0
  v_mov_b32 v47, 0
  v_mov_b32 v48, 0
  v_mov_b32 v49, 0
  v_mov_b32 v50, 0
  v_mov_b32 v51, 0
  v_mov_b32 v52, 0
  v_mov_b32 v53, 0
  v_mov_b32 v54, 0
  v_mov_b32 v55, 0
  v_mov_b32 v56, 0
  v_mov_b32 v57, 0
  v_mov_b32 v58, 0
  v_mov_b32 v59, 0
  v_mov_b32 v60, 0
  v_mov_b32 v61, 0
  v_mov_b32 v62, 0
  v_mov_b32 v63, 0
  v_mov_b32 v64, 0
  v_mov_b32 v65, 0
  v_mov_b32 v66, 0
  v_mov_b32 v67, 0
  v_mov_b32 v68, 0
  v_mov_b32 v69, 0
  v_mov_b32 v70, 0
  v_mov_b32 v71, 0
  v_mov_b32 v72, 0
  v_mov_b32 v73, 0
  v_mov_b32 v74, 0
  v_mov_b32 v75, 0
  v_bfe_u32 v11, v0, 2, 2
  v_lshrrev_b32 v10, 4, v0
  v_lshlrev_b32 v11, 8, v11
  v_lshl_add_u32 v11, v10, 4, v11
  s_waitcnt lgkmcnt(0)
  s_load_dword s60, s[58:59], 0
  s_add_u32 s61, s61, 0x9e3779b9
  s_barrier
sequential_preLN__gqa_block_cached__mixer_token_mlp__decode_kernel_join:
  ds_read_b128 v[28:31], v11 offset:1024
  ds_read_b128 v[32:35], v11 offset:1088
  ds_read_b128 v[36:39], v11 offset:1152
  ds_read_b128 v[40:43], v11 offset:1216
  v_mov_b32 v10, 0
  ds_read_b32 v10, v10 offset:2048
  s_waitcnt lgkmcnt(0)
  v_readfirstlane_b32 s62, v10
  s_lshl_b32 s60, s60, 16
  s_cmp_eq_u32 s3, 0
  s_cbranch_scc1 sequential_preLN__gqa_block_cached__mixer_token_mlp__decode_kernel_w0wait
  v_lshl_add_u32 v108, v0, 4, s24
  s_setprio 3
  s_waitcnt vmcnt(50)
  v_mfma_f32_16x16x32_bf16 v[12:15], v[112:115], v[28:31], 0
  v_mfma_f32_16x16x32_bf16 v[16:19], v[128:131], v[28:31], 0
  v_mfma_f32_16x16x32_bf16 v[12:15], v[116:119], v[32:35], v[12:15]
  v_mfma_f32_16x16x32_bf16 v[16:19], v[132:135], v[32:35], v[16:19]
  v_mfma_f32_16x16x32_bf16 v[12:15], v[120:123], v[36:39], v[12:15]
  v_mfma_f32_16x16x32_bf16 v[16:19], v[136:139], v[36:39], v[16:19]
  v_mfma_f32_16x16x32_bf16 v[12:15], v[124:127], v[40:43], v[12:15]
  v_mfma_f32_16x16x32_bf16 v[16:19], v[140:143], v[40:43], v[16:19]
  buffer_load_dwordx4 v[112:115], v1, s[8:11], 0 offen offset:0 nt
  buffer_load_dwordx4 v[116:119], v1, s[8:11], 0 offen offset:64 nt
  buffer_load_dwordx4 v[120:123], v1, s[8:11], 0 offen offset:128 nt
  buffer_load_dwordx4 v[124:127], v1, s[8:11], 0 offen offset:192 nt
  buffer_load_dwordx4 v[128:131], v2, s[8:11], 0 offen offset:0 nt
  buffer_load_dwordx4 v[132:135], v2, s[8:11], 0 offen offset:64 nt
  buffer_load_dwordx4 v[136:139], v2, s[8:11], 0 offen offset:128 nt
  buffer_load_dwordx4 v[140:143], v2, s[8:11], 0 offen offset:192 nt
  v_add_u32 v1, s22, v1
  v_add_u32 v2, s22, v2
  v_cvt_pk_bf16_f32 v24, v12, v13
  v_cvt_pk_bf16_f32 v25, v14, v15
  v_cvt_pk_bf16_f32 v26, v16, v17
  v_cvt_pk_bf16_f32 v27, v18, v19
  v_lshlrev_b32 v12, 16, v24
  v_and_b32 v13, 0xffff0000, v24
  v_lshlrev_b32 v14, 16, v25
  v_and_b32 v15, 0xffff0000, v25
  v_lshlrev_b32 v16, 16, v26
  v_and_b32 v17, 0xffff0000, v26
  v_lshlrev_b32 v18, 16, v27
  v_and_b32 v19, 0xffff0000, v27
  v_mul_f32 v12, s28, v12
  v_mul_f32 v13, s28, v13
  v_mul_f32 v14, s28, v14
  v_mul_f32 v15, s28, v15
  v_mul_f32 v16, s28, v16
  v_mul_f32 v17, s28, v17
  v_mul_f32 v18, s28, v18
  v_mul_f32 v19, s28, v19
  v_cvt_pk_bf16_f32 v24, v12, v13
  v_cvt_pk_bf16_f32 v25, v14, v15
  v_cvt_pk_bf16_f32 v26, v16, v17
  v_cvt_pk_bf16_f32 v27, v18, v19
  v_lshlrev_b32 v12, 16, v24
  v_and_b32 v13, 0xffff0000, v24
  v_lshlrev_b32 v14, 16, v25
  v_and_b32 v15, 0xffff0000, v25
  v_lshlrev_b32 v16, 16, v26
  v_and_b32 v17, 0xffff0000, v26
  v_lshlrev_b32 v18, 16, v27
  v_and_b32 v19, 0xffff0000, v27
  v_max3_f32 v9, v5, v12, v13
  v_max3_f32 v9, v9, v14, v15
  v_max3_f32 v9, v9, v16, v17
  v_max3_f32 v9, v9, v18, v19
  v_cmp_gt_f32 vcc, v9, v5
  s_cbranch_vccz sequential_preLN__gqa_block_cached__mixer_token_mlp__decode_kernel_skip0
  v_mov_b32 v11, v9
  s_nop 1
  v_permlane16_swap_b32 v9, v11
  v_max_f32 v9, v9, v11
  v_mov_b32 v11, v9
  s_nop 1
  v_permlane32_swap_b32 v9, v11
  v_max_f32 v9, v9, v11
  v_sub_f32 v10, v5, v9
  v_mul_f32 v10, s27, v10
  v_exp_f32 v10, v10
  v_mov_b32 v5, v9
  v_mul_f32_e64 v6, -v9, s27
  v_mul_f32 v7, v7, v10
  v_mov_b32_dpp v8, v10 row_newbcast:0 row_mask:0x1 bank_mask:0xf
  v_mov_b32_dpp v8, v10 row_newbcast:4 row_mask:0x2 bank_mask:0xf
  v_mov_b32_dpp v8, v10 row_newbcast:8 row_mask:0x4 bank_mask:0xf
  v_mov_b32_dpp v8, v10 row_newbcast:12 row_mask:0x8 bank_mask:0xf
  v_mul_f32 v44, v8, v44
  v_mul_f32 v48, v8, v48
  v_mul_f32 v52, v8, v52
  v_mul_f32 v56, v8, v56
  v_mul_f32 v60, v8, v60
  v_mul_f32 v64, v8, v64
  v_mul_f32 v68, v8, v68
  v_mul_f32 v72, v8, v72
sequential_preLN__gqa_block_cached__mixer_token_mlp__decode_kernel_skip0:
  v_fma_f32 v12, v12, s27, v6
  v_fma_f32 v13, v13, s27, v6
  v_fma_f32 v14, v14, s27, v6
  v_fma_f32 v15, v15, s27, v6
  v_fma_f32 v16, v16, s27, v6
  v_fma_f32 v17, v17, s27, v6
  v_fma_f32 v18, v18, s27, v6
  v_fma_f32 v19, v19, s27, v6
  v_exp_f32 v12, v12
  v_exp_f32 v13, v13
  v_exp_f32 v14, v14
  v_exp_f32 v15, v15
  v_exp_f32 v16, v16
  v_exp_f32 v17, v17
  v_exp_f32 v18, v18
  v_exp_f32 v19, v19
  v_cvt_pk_bf16_f32 v20, v12, v13
  v_cvt_pk_bf16_f32 v21, v14, v15
  v_cvt_pk_bf16_f32 v22, v16, v17
  v_cvt_pk_bf16_f32 v23, v18, v19
  v_add_f32 v24, v12, v13
  v_add_f32 v25, v14, v15
  v_add_f32 v26, v16, v17
  v_add_f32 v27, v18, v19
  v_add_f32 v24, v24, v25
  v_add_f32 v26, v26, v27
  v_add_f32 v24, v24, v26
  v_add_f32 v7, v7, v24
  s_waitcnt vmcnt(50)
  v_perm_b32 v76, v148, v144, s25
  v_perm_b32 v80, v148, v144, s26
  v_perm_b32 v77, v156, v152, s25
  v_perm_b32 v81, v156, v152, s26
  v_perm_b32 v78, v164, v160, s25
  v_perm_b32 v82, v164, v160, s26
  v_perm_b32 v79, v172, v168, s25
  v_perm_b32 v83, v172, v168, s26
  v_perm_b32 v84, v149, v145, s25
  v_perm_b32 v88, v149, v145, s26
  v_perm_b32 v85, v157, v153, s25
  v_perm_b32 v89, v157, v153, s26
  v_perm_b32 v86, v165, v161, s25
  v_perm_b32 v90, v165, v161, s26
  v_perm_b32 v87, v173, v169, s25
  v_perm_b32 v91, v173, v169, s26
  v_perm_b32 v92, v150, v146, s25
  v_perm_b32 v96, v150, v146, s26
  v_perm_b32 v93, v158, v154, s25
  v_perm_b32 v97, v158, v154, s26
  v_perm_b32 v94, v166, v162, s25
  v_perm_b32 v98, v166, v162, s26
  v_perm_b32 v95, v174, v170, s25
  v_perm_b32 v99, v174, v170, s26
  v_perm_b32 v100, v151, v147, s25
  v_perm_b32 v104, v151, v147, s26
  v_perm_b32 v101, v159, v155, s25
  v_perm_b32 v105, v159, v155, s26
  v_perm_b32 v102, v167, v163, s25
  v_perm_b32 v106, v167, v163, s26
  v_perm_b32 v103, v175, v171, s25
  v_perm_b32 v107, v175, v171, s26
  buffer_load_dwordx4 v[144:147], v3, s[12:15], 0 offen offset:0 nt
  buffer_load_dwordx4 v[148:151], v3, s[12:15], 0 offen offset:1024 nt
  buffer_load_dwordx4 v[152:155], v3, s[12:15], 0 offen offset:2048 nt
  buffer_load_dwordx4 v[156:159], v3, s[12:15], 0 offen offset:3072 nt
  buffer_load_dwordx4 v[160:163], v4, s[12:15], 0 offen offset:0 nt
  buffer_load_dwordx4 v[164:167], v4, s[12:15], 0 offen offset:1024 nt
  buffer_load_dwordx4 v[168:171], v4, s[12:15], 0 offen offset:2048 nt
  buffer_load_dwordx4 v[172:175], v4, s[12:15], 0 offen offset:3072 nt
  v_add_u32 v3, s22, v3
  v_add_u32 v4, s22, v4
  v_mfma_f32_16x16x32_bf16 v[44:47], v[20:23], v[76:79], v[44:47]
  v_mfma_f32_16x16x32_bf16 v[48:51], v[20:23], v[80:83], v[48:51]
  v_mfma_f32_16x16x32_bf16 v[52:55], v[20:23], v[84:87], v[52:55]
  v_mfma_f32_16x16x32_bf16 v[56:59], v[20:23], v[88:91], v[56:59]
  v_mfma_f32_16x16x32_bf16 v[60:63], v[20:23], v[92:95], v[60:63]
  v_mfma_f32_16x16x32_bf16 v[64:67], v[20:23], v[96:99], v[64:67]
  v_mfma_f32_16x16x32_bf16 v[68:71], v[20:23], v[100:103], v[68:71]
  v_mfma_f32_16x16x32_bf16 v[72:75], v[20:23], v[104:107], v[72:75]
  s_waitcnt vmcnt(50)
  v_mfma_f32_16x16x32_bf16 v[12:15], v[176:179], v[28:31], 0
  v_mfma_f32_16x16x32_bf16 v[16:19], v[192:195], v[28:31], 0
  v_mfma_f32_16x16x32_bf16 v[12:15], v[180:183], v[32:35], v[12:15]
  v_mfma_f32_16x16x32_bf16 v[16:19], v[196:199], v[32:35], v[16:19]
  v_mfma_f32_16x16x32_bf16 v[12:15], v[184:187], v[36:39], v[12:15]
  v_mfma_f32_16x16x32_bf16 v[16:19], v[200:203], v[36:39], v[16:19]
  v_mfma_f32_16x16x32_bf16 v[12:15], v[188:191], v[40:43], v[12:15]
  v_mfma_f32_16x16x32_bf16 v[16:19], v[204:207], v[40:43], v[16:19]
  buffer_load_dwordx4 v[176:179], v1, s[8:11], 0 offen offset:0 nt
  buffer_load_dwordx4 v[180:183], v1, s[8:11], 0 offen offset:64 nt
  buffer_load_dwordx4 v[184:187], v1, s[8:11], 0 offen offset:128 nt
  buffer_load_dwordx4 v[188:191], v1, s[8:11], 0 offen offset:192 nt
  buffer_load_dwordx4 v[192:195], v2, s[8:11], 0 offen offset:0 nt
  buffer_load_dwordx4 v[196:199], v2, s[8:11], 0 offen offset:64 nt
  buffer_load_dwordx4 v[200:203], v2, s[8:11], 0 offen offset:128 nt
  buffer_load_dwordx4 v[204:207], v2, s[8:11], 0 offen offset:192 nt
  v_add_u32 v1, s22, v1
  v_add_u32 v2, s22, v2
  v_cvt_pk_bf16_f32 v24, v12, v13
  v_cvt_pk_bf16_f32 v25, v14, v15
  v_cvt_pk_bf16_f32 v26, v16, v17
  v_cvt_pk_bf16_f32 v27, v18, v19
  v_lshlrev_b32 v12, 16, v24
  v_and_b32 v13, 0xffff0000, v24
  v_lshlrev_b32 v14, 16, v25
  v_and_b32 v15, 0xffff0000, v25
  v_lshlrev_b32 v16, 16, v26
  v_and_b32 v17, 0xffff0000, v26
  v_lshlrev_b32 v18, 16, v27
  v_and_b32 v19, 0xffff0000, v27
  v_mul_f32 v12, s28, v12
  v_mul_f32 v13, s28, v13
  v_mul_f32 v14, s28, v14
  v_mul_f32 v15, s28, v15
  v_mul_f32 v16, s28, v16
  v_mul_f32 v17, s28, v17
  v_mul_f32 v18, s28, v18
  v_mul_f32 v19, s28, v19
  v_cvt_pk_bf16_f32 v24, v12, v13
  v_cvt_pk_bf16_f32 v25, v14, v15
  v_cvt_pk_bf16_f32 v26, v16, v17
  v_cvt_pk_bf16_f32 v27, v18, v19
  v_lshlrev_b32 v12, 16, v24
  v_and_b32 v13, 0xffff0000, v24
  v_lshlrev_b32 v14, 16, v25
  v_and_b32 v15, 0xffff0000, v25
  v_lshlrev_b32 v16, 16, v26
  v_and_b32 v17, 0xffff0000, v26
  v_lshlrev_b32 v18, 16, v27
  v_and_b32 v19, 0xffff0000, v27
  v_max3_f32 v9, v5, v12, v13
  v_max3_f32 v9, v9, v14, v15
  v_max3_f32 v9, v9, v16, v17
  v_max3_f32 v9, v9, v18, v19
  v_cmp_gt_f32 vcc, v9, v5
  s_cbranch_vccz sequential_preLN__gqa_block_cached__mixer_token_mlp__decode_kernel_skip1
  v_mov_b32 v11, v9
  s_nop 1
  v_permlane16_swap_b32 v9, v11
  v_max_f32 v9, v9, v11
  v_mov_b32 v11, v9
  s_nop 1
  v_permlane32_swap_b32 v9, v11
  v_max_f32 v9, v9, v11
  v_sub_f32 v10, v5, v9
  v_mul_f32 v10, s27, v10
  v_exp_f32 v10, v10
  v_mov_b32 v5, v9
  v_mul_f32_e64 v6, -v9, s27
  v_mul_f32 v7, v7, v10
  v_mov_b32_dpp v8, v10 row_newbcast:0 row_mask:0x1 bank_mask:0xf
  v_mov_b32_dpp v8, v10 row_newbcast:4 row_mask:0x2 bank_mask:0xf
  v_mov_b32_dpp v8, v10 row_newbcast:8 row_mask:0x4 bank_mask:0xf
  v_mov_b32_dpp v8, v10 row_newbcast:12 row_mask:0x8 bank_mask:0xf
  v_mul_f32 v44, v8, v44
  v_mul_f32 v48, v8, v48
  v_mul_f32 v52, v8, v52
  v_mul_f32 v56, v8, v56
  v_mul_f32 v60, v8, v60
  v_mul_f32 v64, v8, v64
  v_mul_f32 v68, v8, v68
  v_mul_f32 v72, v8, v72
sequential_preLN__gqa_block_cached__mixer_token_mlp__decode_kernel_skip1:
  v_fma_f32 v12, v12, s27, v6
  v_fma_f32 v13, v13, s27, v6
  v_fma_f32 v14, v14, s27, v6
  v_fma_f32 v15, v15, s27, v6
  v_fma_f32 v16, v16, s27, v6
  v_fma_f32 v17, v17, s27, v6
  v_fma_f32 v18, v18, s27, v6
  v_fma_f32 v19, v19, s27, v6
  v_exp_f32 v12, v12
  v_exp_f32 v13, v13
  v_exp_f32 v14, v14
  v_exp_f32 v15, v15
  v_exp_f32 v16, v16
  v_exp_f32 v17, v17
  v_exp_f32 v18, v18
  v_exp_f32 v19, v19
  v_cvt_pk_bf16_f32 v20, v12, v13
  v_cvt_pk_bf16_f32 v21, v14, v15
  v_cvt_pk_bf16_f32 v22, v16, v17
  v_cvt_pk_bf16_f32 v23, v18, v19
  v_add_f32 v24, v12, v13
  v_add_f32 v25, v14, v15
  v_add_f32 v26, v16, v17
  v_add_f32 v27, v18, v19
  v_add_f32 v24, v24, v25
  v_add_f32 v26, v26, v27
  v_add_f32 v24, v24, v26
  v_add_f32 v7, v7, v24
  s_waitcnt vmcnt(50)
  v_perm_b32 v76, v212, v208, s25
  v_perm_b32 v80, v212, v208, s26
  v_perm_b32 v77, v220, v216, s25
  v_perm_b32 v81, v220, v216, s26
  v_perm_b32 v78, v228, v224, s25
  v_perm_b32 v82, v228, v224, s26
  v_perm_b32 v79, v236, v232, s25
  v_perm_b32 v83, v236, v232, s26
  v_perm_b32 v84, v213, v209, s25
  v_perm_b32 v88, v213, v209, s26
  v_perm_b32 v85, v221, v217, s25
  v_perm_b32 v89, v221, v217, s26
  v_perm_b32 v86, v229, v225, s25
  v_perm_b32 v90, v229, v225, s26
  v_perm_b32 v87, v237, v233, s25
  v_perm_b32 v91, v237, v233, s26
  v_perm_b32 v92, v214, v210, s25
  v_perm_b32 v96, v214, v210, s26
  v_perm_b32 v93, v222, v218, s25
  v_perm_b32 v97, v222, v218, s26
  v_perm_b32 v94, v230, v226, s25
  v_perm_b32 v98, v230, v226, s26
  v_perm_b32 v95, v238, v234, s25
  v_perm_b32 v99, v238, v234, s26
  v_perm_b32 v100, v215, v211, s25
  v_perm_b32 v104, v215, v211, s26
  v_perm_b32 v101, v223, v219, s25
  v_perm_b32 v105, v223, v219, s26
  v_perm_b32 v102, v231, v227, s25
  v_perm_b32 v106, v231, v227, s26
  v_perm_b32 v103, v239, v235, s25
  v_perm_b32 v107, v239, v235, s26
  buffer_load_dwordx4 v[208:211], v3, s[12:15], 0 offen offset:0 nt
  buffer_load_dwordx4 v[212:215], v3, s[12:15], 0 offen offset:1024 nt
  buffer_load_dwordx4 v[216:219], v3, s[12:15], 0 offen offset:2048 nt
  buffer_load_dwordx4 v[220:223], v3, s[12:15], 0 offen offset:3072 nt
  buffer_load_dwordx4 v[224:227], v4, s[12:15], 0 offen offset:0 nt
  buffer_load_dwordx4 v[228:231], v4, s[12:15], 0 offen offset:1024 nt
  buffer_load_dwordx4 v[232:235], v4, s[12:15], 0 offen offset:2048 nt
  buffer_load_dwordx4 v[236:239], v4, s[12:15], 0 offen offset:3072 nt
  v_add_u32 v3, s22, v3
  v_add_u32 v4, s22, v4
  v_mfma_f32_16x16x32_bf16 v[44:47], v[20:23], v[76:79], v[44:47]
  v_mfma_f32_16x16x32_bf16 v[48:51], v[20:23], v[80:83], v[48:51]
  v_mfma_f32_16x16x32_bf16 v[52:55], v[20:23], v[84:87], v[52:55]
  v_mfma_f32_16x16x32_bf16 v[56:59], v[20:23], v[88:91], v[56:59]
  v_mfma_f32_16x16x32_bf16 v[60:63], v[20:23], v[92:95], v[60:63]
  v_mfma_f32_16x16x32_bf16 v[64:67], v[20:23], v[96:99], v[64:67]
  v_mfma_f32_16x16x32_bf16 v[68:71], v[20:23], v[100:103], v[68:71]
  v_mfma_f32_16x16x32_bf16 v[72:75], v[20:23], v[104:107], v[72:75]
  s_setprio 2
  s_waitcnt vmcnt(24)
  v_mfma_f32_16x16x32_bf16 v[12:15], v[112:115], v[28:31], 0
  v_mfma_f32_16x16x32_bf16 v[16:19], v[128:131], v[28:31], 0
  v_mfma_f32_16x16x32_bf16 v[12:15], v[116:119], v[32:35], v[12:15]
  v_mfma_f32_16x16x32_bf16 v[16:19], v[132:135], v[32:35], v[16:19]
  v_mfma_f32_16x16x32_bf16 v[12:15], v[120:123], v[36:39], v[12:15]
  v_mfma_f32_16x16x32_bf16 v[16:19], v[136:139], v[36:39], v[16:19]
  v_mfma_f32_16x16x32_bf16 v[12:15], v[124:127], v[40:43], v[12:15]
  v_mfma_f32_16x16x32_bf16 v[16:19], v[140:143], v[40:43], v[16:19]
  buffer_load_dwordx4 v[112:115], v1, s[8:11], 0 offen offset:0 nt
  buffer_load_dwordx4 v[116:119], v1, s[8:11], 0 offen offset:64 nt
  buffer_load_dwordx4 v[120:123], v1, s[8:11], 0 offen offset:128 nt
  buffer_load_dwordx4 v[124:127], v1, s[8:11], 0 offen offset:192 nt
  buffer_load_dwordx4 v[128:131], v2, s[8:11], 0 offen offset:0 nt
  buffer_load_dwordx4 v[132:135], v2, s[8:11], 0 offen offset:64 nt
  buffer_load_dwordx4 v[136:139], v2, s[8:11], 0 offen offset:128 nt
  buffer_load_dwordx4 v[140:143], v2, s[8:11], 0 offen offset:192 nt
  v_add_u32 v1, s22, v1
  v_add_u32 v2, s22, v2
  v_cvt_pk_bf16_f32 v24, v12, v13
  v_cvt_pk_bf16_f32 v25, v14, v15
  v_cvt_pk_bf16_f32 v26, v16, v17
  v_cvt_pk_bf16_f32 v27, v18, v19
  v_lshlrev_b32 v12, 16, v24
  v_and_b32 v13, 0xffff0000, v24
  v_lshlrev_b32 v14, 16, v25
  v_and_b32 v15, 0xffff0000, v25
  v_lshlrev_b32 v16, 16, v26
  v_and_b32 v17, 0xffff0000, v26
  v_lshlrev_b32 v18, 16, v27
  v_and_b32 v19, 0xffff0000, v27
  v_mul_f32 v12, s28, v12
  v_mul_f32 v13, s28, v13
  v_mul_f32 v14, s28, v14
  v_mul_f32 v15, s28, v15
  v_mul_f32 v16, s28, v16
  v_mul_f32 v17, s28, v17
  v_mul_f32 v18, s28, v18
  v_mul_f32 v19, s28, v19
  v_cvt_pk_bf16_f32 v24, v12, v13
  v_cvt_pk_bf16_f32 v25, v14, v15
  v_cvt_pk_bf16_f32 v26, v16, v17
  v_cvt_pk_bf16_f32 v27, v18, v19
  v_lshlrev_b32 v12, 16, v24
  v_and_b32 v13, 0xffff0000, v24
  v_lshlrev_b32 v14, 16, v25
  v_and_b32 v15, 0xffff0000, v25
  v_lshlrev_b32 v16, 16, v26
  v_and_b32 v17, 0xffff0000, v26
  v_lshlrev_b32 v18, 16, v27
  v_and_b32 v19, 0xffff0000, v27
  v_max3_f32 v9, v5, v12, v13
  v_max3_f32 v9, v9, v14, v15
  v_max3_f32 v9, v9, v16, v17
  v_max3_f32 v9, v9, v18, v19
  v_cmp_gt_f32 vcc, v9, v5
  s_cbranch_vccz sequential_preLN__gqa_block_cached__mixer_token_mlp__decode_kernel_skip2
  v_mov_b32 v11, v9
  s_nop 1
  v_permlane16_swap_b32 v9, v11
  v_max_f32 v9, v9, v11
  v_mov_b32 v11, v9
  s_nop 1
  v_permlane32_swap_b32 v9, v11
  v_max_f32 v9, v9, v11
  v_sub_f32 v10, v5, v9
  v_mul_f32 v10, s27, v10
  v_exp_f32 v10, v10
  v_mov_b32 v5, v9
  v_mul_f32_e64 v6, -v9, s27
  v_mul_f32 v7, v7, v10
  v_mov_b32_dpp v8, v10 row_newbcast:0 row_mask:0x1 bank_mask:0xf
  v_mov_b32_dpp v8, v10 row_newbcast:4 row_mask:0x2 bank_mask:0xf
  v_mov_b32_dpp v8, v10 row_newbcast:8 row_mask:0x4 bank_mask:0xf
  v_mov_b32_dpp v8, v10 row_newbcast:12 row_mask:0x8 bank_mask:0xf
  v_mul_f32 v44, v8, v44
  v_mul_f32 v48, v8, v48
  v_mul_f32 v52, v8, v52
  v_mul_f32 v56, v8, v56
  v_mul_f32 v60, v8, v60
  v_mul_f32 v64, v8, v64
  v_mul_f32 v68, v8, v68
  v_mul_f32 v72, v8, v72
sequential_preLN__gqa_block_cached__mixer_token_mlp__decode_kernel_skip2:
  v_fma_f32 v12, v12, s27, v6
  v_fma_f32 v13, v13, s27, v6
  v_fma_f32 v14, v14, s27, v6
  v_fma_f32 v15, v15, s27, v6
  v_fma_f32 v16, v16, s27, v6
  v_fma_f32 v17, v17, s27, v6
  v_fma_f32 v18, v18, s27, v6
  v_fma_f32 v19, v19, s27, v6
  v_exp_f32 v12, v12
  v_exp_f32 v13, v13
  v_exp_f32 v14, v14
  v_exp_f32 v15, v15
  v_exp_f32 v16, v16
  v_exp_f32 v17, v17
  v_exp_f32 v18, v18
  v_exp_f32 v19, v19
  v_cvt_pk_bf16_f32 v20, v12, v13
  v_cvt_pk_bf16_f32 v21, v14, v15
  v_cvt_pk_bf16_f32 v22, v16, v17
  v_cvt_pk_bf16_f32 v23, v18, v19
  v_add_f32 v24, v12, v13
  v_add_f32 v25, v14, v15
  v_add_f32 v26, v16, v17
  v_add_f32 v27, v18, v19
  v_add_f32 v24, v24, v25
  v_add_f32 v26, v26, v27
  v_add_f32 v24, v24, v26
  v_add_f32 v7, v7, v24
  s_waitcnt vmcnt(24)
  v_perm_b32 v76, v148, v144, s25
  v_perm_b32 v80, v148, v144, s26
  v_perm_b32 v77, v156, v152, s25
  v_perm_b32 v81, v156, v152, s26
  v_perm_b32 v78, v164, v160, s25
  v_perm_b32 v82, v164, v160, s26
  v_perm_b32 v79, v172, v168, s25
  v_perm_b32 v83, v172, v168, s26
  v_perm_b32 v84, v149, v145, s25
  v_perm_b32 v88, v149, v145, s26
  v_perm_b32 v85, v157, v153, s25
  v_perm_b32 v89, v157, v153, s26
  v_perm_b32 v86, v165, v161, s25
  v_perm_b32 v90, v165, v161, s26
  v_perm_b32 v87, v173, v169, s25
  v_perm_b32 v91, v173, v169, s26
  v_perm_b32 v92, v150, v146, s25
  v_perm_b32 v96, v150, v146, s26
  v_perm_b32 v93, v158, v154, s25
  v_perm_b32 v97, v158, v154, s26
  v_perm_b32 v94, v166, v162, s25
  v_perm_b32 v98, v166, v162, s26
  v_perm_b32 v95, v174, v170, s25
  v_perm_b32 v99, v174, v170, s26
  v_perm_b32 v100, v151, v147, s25
  v_perm_b32 v104, v151, v147, s26
  v_perm_b32 v101, v159, v155, s25
  v_perm_b32 v105, v159, v155, s26
  v_perm_b32 v102, v167, v163, s25
  v_perm_b32 v106, v167, v163, s26
  v_perm_b32 v103, v175, v171, s25
  v_perm_b32 v107, v175, v171, s26
  buffer_load_dwordx4 v[144:147], v3, s[12:15], 0 offen offset:0 nt
  buffer_load_dwordx4 v[148:151], v3, s[12:15], 0 offen offset:1024 nt
  buffer_load_dwordx4 v[152:155], v3, s[12:15], 0 offen offset:2048 nt
  buffer_load_dwordx4 v[156:159], v3, s[12:15], 0 offen offset:3072 nt
  buffer_load_dwordx4 v[160:163], v4, s[12:15], 0 offen offset:0 nt
  buffer_load_dwordx4 v[164:167], v4, s[12:15], 0 offen offset:1024 nt
  buffer_load_dwordx4 v[168:171], v4, s[12:15], 0 offen offset:2048 nt
  buffer_load_dwordx4 v[172:175], v4, s[12:15], 0 offen offset:3072 nt
  v_add_u32 v3, s22, v3
  v_add_u32 v4, s22, v4
  v_mfma_f32_16x16x32_bf16 v[44:47], v[20:23], v[76:79], v[44:47]
  v_mfma_f32_16x16x32_bf16 v[48:51], v[20:23], v[80:83], v[48:51]
  v_mfma_f32_16x16x32_bf16 v[52:55], v[20:23], v[84:87], v[52:55]
  v_mfma_f32_16x16x32_bf16 v[56:59], v[20:23], v[88:91], v[56:59]
  v_mfma_f32_16x16x32_bf16 v[60:63], v[20:23], v[92:95], v[60:63]
  v_mfma_f32_16x16x32_bf16 v[64:67], v[20:23], v[96:99], v[64:67]
  v_mfma_f32_16x16x32_bf16 v[68:71], v[20:23], v[100:103], v[68:71]
  v_mfma_f32_16x16x32_bf16 v[72:75], v[20:23], v[104:107], v[72:75]
  s_waitcnt vmcnt(24)
  v_mfma_f32_16x16x32_bf16 v[12:15], v[176:179], v[28:31], 0
  v_mfma_f32_16x16x32_bf16 v[16:19], v[192:195], v[28:31], 0
  v_mfma_f32_16x16x32_bf16 v[12:15], v[180:183], v[32:35], v[12:15]
  v_mfma_f32_16x16x32_bf16 v[16:19], v[196:199], v[32:35], v[16:19]
  v_mfma_f32_16x16x32_bf16 v[12:15], v[184:187], v[36:39], v[12:15]
  v_mfma_f32_16x16x32_bf16 v[16:19], v[200:203], v[36:39], v[16:19]
  v_mfma_f32_16x16x32_bf16 v[12:15], v[188:191], v[40:43], v[12:15]
  v_mfma_f32_16x16x32_bf16 v[16:19], v[204:207], v[40:43], v[16:19]
  buffer_load_dwordx4 v[176:179], v1, s[8:11], 0 offen offset:0 nt
  buffer_load_dwordx4 v[180:183], v1, s[8:11], 0 offen offset:64 nt
  buffer_load_dwordx4 v[184:187], v1, s[8:11], 0 offen offset:128 nt
  buffer_load_dwordx4 v[188:191], v1, s[8:11], 0 offen offset:192 nt
  buffer_load_dwordx4 v[192:195], v2, s[8:11], 0 offen offset:0 nt
  buffer_load_dwordx4 v[196:199], v2, s[8:11], 0 offen offset:64 nt
  buffer_load_dwordx4 v[200:203], v2, s[8:11], 0 offen offset:128 nt
  buffer_load_dwordx4 v[204:207], v2, s[8:11], 0 offen offset:192 nt
  v_add_u32 v1, s22, v1
  v_add_u32 v2, s22, v2
  v_cvt_pk_bf16_f32 v24, v12, v13
  v_cvt_pk_bf16_f32 v25, v14, v15
  v_cvt_pk_bf16_f32 v26, v16, v17
  v_cvt_pk_bf16_f32 v27, v18, v19
  v_lshlrev_b32 v12, 16, v24
  v_and_b32 v13, 0xffff0000, v24
  v_lshlrev_b32 v14, 16, v25
  v_and_b32 v15, 0xffff0000, v25
  v_lshlrev_b32 v16, 16, v26
  v_and_b32 v17, 0xffff0000, v26
  v_lshlrev_b32 v18, 16, v27
  v_and_b32 v19, 0xffff0000, v27
  v_mul_f32 v12, s28, v12
  v_mul_f32 v13, s28, v13
  v_mul_f32 v14, s28, v14
  v_mul_f32 v15, s28, v15
  v_mul_f32 v16, s28, v16
  v_mul_f32 v17, s28, v17
  v_mul_f32 v18, s28, v18
  v_mul_f32 v19, s28, v19
  v_cvt_pk_bf16_f32 v24, v12, v13
  v_cvt_pk_bf16_f32 v25, v14, v15
  v_cvt_pk_bf16_f32 v26, v16, v17
  v_cvt_pk_bf16_f32 v27, v18, v19
  v_lshlrev_b32 v12, 16, v24
  v_and_b32 v13, 0xffff0000, v24
  v_lshlrev_b32 v14, 16, v25
  v_and_b32 v15, 0xffff0000, v25
  v_lshlrev_b32 v16, 16, v26
  v_and_b32 v17, 0xffff0000, v26
  v_lshlrev_b32 v18, 16, v27
  v_and_b32 v19, 0xffff0000, v27
  v_max3_f32 v9, v5, v12, v13
  v_max3_f32 v9, v9, v14, v15
  v_max3_f32 v9, v9, v16, v17
  v_max3_f32 v9, v9, v18, v19
  v_cmp_gt_f32 vcc, v9, v5
  s_cbranch_vccz sequential_preLN__gqa_block_cached__mixer_token_mlp__decode_kernel_skip3
  v_mov_b32 v11, v9
  s_nop 1
  v_permlane16_swap_b32 v9, v11
  v_max_f32 v9, v9, v11
  v_mov_b32 v11, v9
  s_nop 1
  v_permlane32_swap_b32 v9, v11
  v_max_f32 v9, v9, v11
  v_sub_f32 v10, v5, v9
  v_mul_f32 v10, s27, v10
  v_exp_f32 v10, v10
  v_mov_b32 v5, v9
  v_mul_f32_e64 v6, -v9, s27
  v_mul_f32 v7, v7, v10
  v_mov_b32_dpp v8, v10 row_newbcast:0 row_mask:0x1 bank_mask:0xf
  v_mov_b32_dpp v8, v10 row_newbcast:4 row_mask:0x2 bank_mask:0xf
  v_mov_b32_dpp v8, v10 row_newbcast:8 row_mask:0x4 bank_mask:0xf
  v_mov_b32_dpp v8, v10 row_newbcast:12 row_mask:0x8 bank_mask:0xf
  v_mul_f32 v44, v8, v44
  v_mul_f32 v48, v8, v48
  v_mul_f32 v52, v8, v52
  v_mul_f32 v56, v8, v56
  v_mul_f32 v60, v8, v60
  v_mul_f32 v64, v8, v64
  v_mul_f32 v68, v8, v68
  v_mul_f32 v72, v8, v72
sequential_preLN__gqa_block_cached__mixer_token_mlp__decode_kernel_skip3:
  v_fma_f32 v12, v12, s27, v6
  v_fma_f32 v13, v13, s27, v6
  v_fma_f32 v14, v14, s27, v6
  v_fma_f32 v15, v15, s27, v6
  v_fma_f32 v16, v16, s27, v6
  v_fma_f32 v17, v17, s27, v6
  v_fma_f32 v18, v18, s27, v6
  v_fma_f32 v19, v19, s27, v6
  v_exp_f32 v12, v12
  v_exp_f32 v13, v13
  v_exp_f32 v14, v14
  v_exp_f32 v15, v15
  v_exp_f32 v16, v16
  v_exp_f32 v17, v17
  v_exp_f32 v18, v18
  v_exp_f32 v19, v19
  v_cvt_pk_bf16_f32 v20, v12, v13
  v_cvt_pk_bf16_f32 v21, v14, v15
  v_cvt_pk_bf16_f32 v22, v16, v17
  v_cvt_pk_bf16_f32 v23, v18, v19
  v_add_f32 v24, v12, v13
  v_add_f32 v25, v14, v15
  v_add_f32 v26, v16, v17
  v_add_f32 v27, v18, v19
  v_add_f32 v24, v24, v25
  v_add_f32 v26, v26, v27
  v_add_f32 v24, v24, v26
  v_add_f32 v7, v7, v24
  s_waitcnt vmcnt(24)
  v_perm_b32 v76, v212, v208, s25
  v_perm_b32 v80, v212, v208, s26
  v_perm_b32 v77, v220, v216, s25
  v_perm_b32 v81, v220, v216, s26
  v_perm_b32 v78, v228, v224, s25
  v_perm_b32 v82, v228, v224, s26
  v_perm_b32 v79, v236, v232, s25
  v_perm_b32 v83, v236, v232, s26
  v_perm_b32 v84, v213, v209, s25
  v_perm_b32 v88, v213, v209, s26
  v_perm_b32 v85, v221, v217, s25
  v_perm_b32 v89, v221, v217, s26
  v_perm_b32 v86, v229, v225, s25
  v_perm_b32 v90, v229, v225, s26
  v_perm_b32 v87, v237, v233, s25
  v_perm_b32 v91, v237, v233, s26
  v_perm_b32 v92, v214, v210, s25
  v_perm_b32 v96, v214, v210, s26
  v_perm_b32 v93, v222, v218, s25
  v_perm_b32 v97, v222, v218, s26
  v_perm_b32 v94, v230, v226, s25
  v_perm_b32 v98, v230, v226, s26
  v_perm_b32 v95, v238, v234, s25
  v_perm_b32 v99, v238, v234, s26
  v_perm_b32 v100, v215, v211, s25
  v_perm_b32 v104, v215, v211, s26
  v_perm_b32 v101, v223, v219, s25
  v_perm_b32 v105, v223, v219, s26
  v_perm_b32 v102, v231, v227, s25
  v_perm_b32 v106, v231, v227, s26
  v_perm_b32 v103, v239, v235, s25
  v_perm_b32 v107, v239, v235, s26
  buffer_load_dwordx4 v[208:211], v3, s[12:15], 0 offen offset:0 nt
  buffer_load_dwordx4 v[212:215], v3, s[12:15], 0 offen offset:1024 nt
  buffer_load_dwordx4 v[216:219], v3, s[12:15], 0 offen offset:2048 nt
  buffer_load_dwordx4 v[220:223], v3, s[12:15], 0 offen offset:3072 nt
  buffer_load_dwordx4 v[224:227], v4, s[12:15], 0 offen offset:0 nt
  buffer_load_dwordx4 v[228:231], v4, s[12:15], 0 offen offset:1024 nt
  buffer_load_dwordx4 v[232:235], v4, s[12:15], 0 offen offset:2048 nt
  buffer_load_dwordx4 v[236:239], v4, s[12:15], 0 offen offset:3072 nt
  v_add_u32 v3, s22, v3
  v_add_u32 v4, s22, v4
  v_mfma_f32_16x16x32_bf16 v[44:47], v[20:23], v[76:79], v[44:47]
  v_mfma_f32_16x16x32_bf16 v[48:51], v[20:23], v[80:83], v[48:51]
  v_mfma_f32_16x16x32_bf16 v[52:55], v[20:23], v[84:87], v[52:55]
  v_mfma_f32_16x16x32_bf16 v[56:59], v[20:23], v[88:91], v[56:59]
  v_mfma_f32_16x16x32_bf16 v[60:63], v[20:23], v[92:95], v[60:63]
  v_mfma_f32_16x16x32_bf16 v[64:67], v[20:23], v[96:99], v[64:67]
  v_mfma_f32_16x16x32_bf16 v[68:71], v[20:23], v[100:103], v[68:71]
  v_mfma_f32_16x16x32_bf16 v[72:75], v[20:23], v[104:107], v[72:75]
  s_setprio 1
  s_waitcnt vmcnt(24)
  v_mfma_f32_16x16x32_bf16 v[12:15], v[112:115], v[28:31], 0
  v_mfma_f32_16x16x32_bf16 v[16:19], v[128:131], v[28:31], 0
  v_mfma_f32_16x16x32_bf16 v[12:15], v[116:119], v[32:35], v[12:15]
  v_mfma_f32_16x16x32_bf16 v[16:19], v[132:135], v[32:35], v[16:19]
  v_mfma_f32_16x16x32_bf16 v[12:15], v[120:123], v[36:39], v[12:15]
  v_mfma_f32_16x16x32_bf16 v[16:19], v[136:139], v[36:39], v[16:19]
  v_mfma_f32_16x16x32_bf16 v[12:15], v[124:127], v[40:43], v[12:15]
  v_mfma_f32_16x16x32_bf16 v[16:19], v[140:143], v[40:43], v[16:19]
  buffer_load_dwordx4 v[112:115], v1, s[8:11], 0 offen offset:0 nt
  buffer_load_dwordx4 v[116:119], v1, s[8:11], 0 offen offset:64 nt
  buffer_load_dwordx4 v[120:123], v1, s[8:11], 0 offen offset:128 nt
  buffer_load_dwordx4 v[124:127], v1, s[8:11], 0 offen offset:192 nt
  buffer_load_dwordx4 v[128:131], v2, s[8:11], 0 offen offset:0 nt
  buffer_load_dwordx4 v[132:135], v2, s[8:11], 0 offen offset:64 nt
  buffer_load_dwordx4 v[136:139], v2, s[8:11], 0 offen offset:128 nt
  buffer_load_dwordx4 v[140:143], v2, s[8:11], 0 offen offset:192 nt
  v_add_u32 v1, s22, v1
  v_add_u32 v2, s22, v2
  v_cvt_pk_bf16_f32 v24, v12, v13
  v_cvt_pk_bf16_f32 v25, v14, v15
  v_cvt_pk_bf16_f32 v26, v16, v17
  v_cvt_pk_bf16_f32 v27, v18, v19
  v_lshlrev_b32 v12, 16, v24
  v_and_b32 v13, 0xffff0000, v24
  v_lshlrev_b32 v14, 16, v25
  v_and_b32 v15, 0xffff0000, v25
  v_lshlrev_b32 v16, 16, v26
  v_and_b32 v17, 0xffff0000, v26
  v_lshlrev_b32 v18, 16, v27
  v_and_b32 v19, 0xffff0000, v27
  v_mul_f32 v12, s28, v12
  v_mul_f32 v13, s28, v13
  v_mul_f32 v14, s28, v14
  v_mul_f32 v15, s28, v15
  v_mul_f32 v16, s28, v16
  v_mul_f32 v17, s28, v17
  v_mul_f32 v18, s28, v18
  v_mul_f32 v19, s28, v19
  v_cvt_pk_bf16_f32 v24, v12, v13
  v_cvt_pk_bf16_f32 v25, v14, v15
  v_cvt_pk_bf16_f32 v26, v16, v17
  v_cvt_pk_bf16_f32 v27, v18, v19
  v_lshlrev_b32 v12, 16, v24
  v_and_b32 v13, 0xffff0000, v24
  v_lshlrev_b32 v14, 16, v25
  v_and_b32 v15, 0xffff0000, v25
  v_lshlrev_b32 v16, 16, v26
  v_and_b32 v17, 0xffff0000, v26
  v_lshlrev_b32 v18, 16, v27
  v_and_b32 v19, 0xffff0000, v27
  v_max3_f32 v9, v5, v12, v13
  v_max3_f32 v9, v9, v14, v15
  v_max3_f32 v9, v9, v16, v17
  v_max3_f32 v9, v9, v18, v19
  v_cmp_gt_f32 vcc, v9, v5
  s_cbranch_vccz sequential_preLN__gqa_block_cached__mixer_token_mlp__decode_kernel_skip4
  v_mov_b32 v11, v9
  s_nop 1
  v_permlane16_swap_b32 v9, v11
  v_max_f32 v9, v9, v11
  v_mov_b32 v11, v9
  s_nop 1
  v_permlane32_swap_b32 v9, v11
  v_max_f32 v9, v9, v11
  v_sub_f32 v10, v5, v9
  v_mul_f32 v10, s27, v10
  v_exp_f32 v10, v10
  v_mov_b32 v5, v9
  v_mul_f32_e64 v6, -v9, s27
  v_mul_f32 v7, v7, v10
  v_mov_b32_dpp v8, v10 row_newbcast:0 row_mask:0x1 bank_mask:0xf
  v_mov_b32_dpp v8, v10 row_newbcast:4 row_mask:0x2 bank_mask:0xf
  v_mov_b32_dpp v8, v10 row_newbcast:8 row_mask:0x4 bank_mask:0xf
  v_mov_b32_dpp v8, v10 row_newbcast:12 row_mask:0x8 bank_mask:0xf
  v_mul_f32 v44, v8, v44
  v_mul_f32 v48, v8, v48
  v_mul_f32 v52, v8, v52
  v_mul_f32 v56, v8, v56
  v_mul_f32 v60, v8, v60
  v_mul_f32 v64, v8, v64
  v_mul_f32 v68, v8, v68
  v_mul_f32 v72, v8, v72
sequential_preLN__gqa_block_cached__mixer_token_mlp__decode_kernel_skip4:
  v_fma_f32 v12, v12, s27, v6
  v_fma_f32 v13, v13, s27, v6
  v_fma_f32 v14, v14, s27, v6
  v_fma_f32 v15, v15, s27, v6
  v_fma_f32 v16, v16, s27, v6
  v_fma_f32 v17, v17, s27, v6
  v_fma_f32 v18, v18, s27, v6
  v_fma_f32 v19, v19, s27, v6
  v_exp_f32 v12, v12
  v_exp_f32 v13, v13
  v_exp_f32 v14, v14
  v_exp_f32 v15, v15
  v_exp_f32 v16, v16
  v_exp_f32 v17, v17
  v_exp_f32 v18, v18
  v_exp_f32 v19, v19
  v_cvt_pk_bf16_f32 v20, v12, v13
  v_cvt_pk_bf16_f32 v21, v14, v15
  v_cvt_pk_bf16_f32 v22, v16, v17
  v_cvt_pk_bf16_f32 v23, v18, v19
  v_add_f32 v24, v12, v13
  v_add_f32 v25, v14, v15
  v_add_f32 v26, v16, v17
  v_add_f32 v27, v18, v19
  v_add_f32 v24, v24, v25
  v_add_f32 v26, v26, v27
  v_add_f32 v24, v24, v26
  v_add_f32 v7, v7, v24
  s_waitcnt vmcnt(24)
  v_perm_b32 v76, v148, v144, s25
  v_perm_b32 v80, v148, v144, s26
  v_perm_b32 v77, v156, v152, s25
  v_perm_b32 v81, v156, v152, s26
  v_perm_b32 v78, v164, v160, s25
  v_perm_b32 v82, v164, v160, s26
  v_perm_b32 v79, v172, v168, s25
  v_perm_b32 v83, v172, v168, s26
  v_perm_b32 v84, v149, v145, s25
  v_perm_b32 v88, v149, v145, s26
  v_perm_b32 v85, v157, v153, s25
  v_perm_b32 v89, v157, v153, s26
  v_perm_b32 v86, v165, v161, s25
  v_perm_b32 v90, v165, v161, s26
  v_perm_b32 v87, v173, v169, s25
  v_perm_b32 v91, v173, v169, s26
  v_perm_b32 v92, v150, v146, s25
  v_perm_b32 v96, v150, v146, s26
  v_perm_b32 v93, v158, v154, s25
  v_perm_b32 v97, v158, v154, s26
  v_perm_b32 v94, v166, v162, s25
  v_perm_b32 v98, v166, v162, s26
  v_perm_b32 v95, v174, v170, s25
  v_perm_b32 v99, v174, v170, s26
  v_perm_b32 v100, v151, v147, s25
  v_perm_b32 v104, v151, v147, s26
  v_perm_b32 v101, v159, v155, s25
  v_perm_b32 v105, v159, v155, s26
  v_perm_b32 v102, v167, v163, s25
  v_perm_b32 v106, v167, v163, s26
  v_perm_b32 v103, v175, v171, s25
  v_perm_b32 v107, v175, v171, s26
  buffer_load_dwordx4 v[144:147], v3, s[12:15], 0 offen offset:0 nt
  buffer_load_dwordx4 v[148:151], v3, s[12:15], 0 offen offset:1024 nt
  buffer_load_dwordx4 v[152:155], v3, s[12:15], 0 offen offset:2048 nt
  buffer_load_dwordx4 v[156:159], v3, s[12:15], 0 offen offset:3072 nt
  buffer_load_dwordx4 v[160:163], v4, s[12:15], 0 offen offset:0 nt
  buffer_load_dwordx4 v[164:167], v4, s[12:15], 0 offen offset:1024 nt
  buffer_load_dwordx4 v[168:171], v4, s[12:15], 0 offen offset:2048 nt
  buffer_load_dwordx4 v[172:175], v4, s[12:15], 0 offen offset:3072 nt
  v_add_u32 v3, s22, v3
  v_add_u32 v4, s22, v4
  v_mfma_f32_16x16x32_bf16 v[44:47], v[20:23], v[76:79], v[44:47]
  v_mfma_f32_16x16x32_bf16 v[48:51], v[20:23], v[80:83], v[48:51]
  v_mfma_f32_16x16x32_bf16 v[52:55], v[20:23], v[84:87], v[52:55]
  v_mfma_f32_16x16x32_bf16 v[56:59], v[20:23], v[88:91], v[56:59]
  v_mfma_f32_16x16x32_bf16 v[60:63], v[20:23], v[92:95], v[60:63]
  v_mfma_f32_16x16x32_bf16 v[64:67], v[20:23], v[96:99], v[64:67]
  v_mfma_f32_16x16x32_bf16 v[68:71], v[20:23], v[100:103], v[68:71]
  v_mfma_f32_16x16x32_bf16 v[72:75], v[20:23], v[104:107], v[72:75]
  s_waitcnt vmcnt(24)
  v_mfma_f32_16x16x32_bf16 v[12:15], v[176:179], v[28:31], 0
  v_mfma_f32_16x16x32_bf16 v[16:19], v[192:195], v[28:31], 0
  v_mfma_f32_16x16x32_bf16 v[12:15], v[180:183], v[32:35], v[12:15]
  v_mfma_f32_16x16x32_bf16 v[16:19], v[196:199], v[32:35], v[16:19]
  v_mfma_f32_16x16x32_bf16 v[12:15], v[184:187], v[36:39], v[12:15]
  v_mfma_f32_16x16x32_bf16 v[16:19], v[200:203], v[36:39], v[16:19]
  v_mfma_f32_16x16x32_bf16 v[12:15], v[188:191], v[40:43], v[12:15]
  v_mfma_f32_16x16x32_bf16 v[16:19], v[204:207], v[40:43], v[16:19]
  ds_read_b128 v[176:179], v108 offset:0
  ds_read_b128 v[180:183], v108 offset:1024
  ds_read_b128 v[184:187], v108 offset:2048
  ds_read_b128 v[188:191], v108 offset:3072
  ds_read_b128 v[192:195], v108 offset:4096
  ds_read_b128 v[196:199], v108 offset:5120
  ds_read_b128 v[200:203], v108 offset:6144
  ds_read_b128 v[204:207], v108 offset:7168
  v_cvt_pk_bf16_f32 v24, v12, v13
  v_cvt_pk_bf16_f32 v25, v14, v15
  v_cvt_pk_bf16_f32 v26, v16, v17
  v_cvt_pk_bf16_f32 v27, v18, v19
  v_lshlrev_b32 v12, 16, v24
  v_and_b32 v13, 0xffff0000, v24
  v_lshlrev_b32 v14, 16, v25
  v_and_b32 v15, 0xffff0000, v25
  v_lshlrev_b32 v16, 16, v26
  v_and_b32 v17, 0xffff0000, v26
  v_lshlrev_b32 v18, 16, v27
  v_and_b32 v19, 0xffff0000, v27
  v_mul_f32 v12, s28, v12
  v_mul_f32 v13, s28, v13
  v_mul_f32 v14, s28, v14
  v_mul_f32 v15, s28, v15
  v_mul_f32 v16, s28, v16
  v_mul_f32 v17, s28, v17
  v_mul_f32 v18, s28, v18
  v_mul_f32 v19, s28, v19
  v_cvt_pk_bf16_f32 v24, v12, v13
  v_cvt_pk_bf16_f32 v25, v14, v15
  v_cvt_pk_bf16_f32 v26, v16, v17
  v_cvt_pk_bf16_f32 v27, v18, v19
  v_lshlrev_b32 v12, 16, v24
  v_and_b32 v13, 0xffff0000, v24
  v_lshlrev_b32 v14, 16, v25
  v_and_b32 v15, 0xffff0000, v25
  v_lshlrev_b32 v16, 16, v26
  v_and_b32 v17, 0xffff0000, v26
  v_lshlrev_b32 v18, 16, v27
  v_and_b32 v19, 0xffff0000, v27
  v_max3_f32 v9, v5, v12, v13
  v_max3_f32 v9, v9, v14, v15
  v_max3_f32 v9, v9, v16, v17
  v_max3_f32 v9, v9, v18, v19
  v_cmp_gt_f32 vcc, v9, v5
  s_cbranch_vccz sequential_preLN__gqa_block_cached__mixer_token_mlp__decode_kernel_skip5
  v_mov_b32 v11, v9
  s_nop 1
  v_permlane16_swap_b32 v9, v11
  v_max_f32 v9, v9, v11
  v_mov_b32 v11, v9
  s_nop 1
  v_permlane32_swap_b32 v9, v11
  v_max_f32 v9, v9, v11
  v_sub_f32 v10, v5, v9
  v_mul_f32 v10, s27, v10
  v_exp_f32 v10, v10
  v_mov_b32 v5, v9
  v_mul_f32_e64 v6, -v9, s27
  v_mul_f32 v7, v7, v10
  v_mov_b32_dpp v8, v10 row_newbcast:0 row_mask:0x1 bank_mask:0xf
  v_mov_b32_dpp v8, v10 row_newbcast:4 row_mask:0x2 bank_mask:0xf
  v_mov_b32_dpp v8, v10 row_newbcast:8 row_mask:0x4 bank_mask:0xf
  v_mov_b32_dpp v8, v10 row_newbcast:12 row_mask:0x8 bank_mask:0xf
  v_mul_f32 v44, v8, v44
  v_mul_f32 v48, v8, v48
  v_mul_f32 v52, v8, v52
  v_mul_f32 v56, v8, v56
  v_mul_f32 v60, v8, v60
  v_mul_f32 v64, v8, v64
  v_mul_f32 v68, v8, v68
  v_mul_f32 v72, v8, v72
sequential_preLN__gqa_block_cached__mixer_token_mlp__decode_kernel_skip5:
  v_fma_f32 v12, v12, s27, v6
  v_fma_f32 v13, v13, s27, v6
  v_fma_f32 v14, v14, s27, v6
  v_fma_f32 v15, v15, s27, v6
  v_fma_f32 v16, v16, s27, v6
  v_fma_f32 v17, v17, s27, v6
  v_fma_f32 v18, v18, s27, v6
  v_fma_f32 v19, v19, s27, v6
  v_exp_f32 v12, v12
  v_exp_f32 v13, v13
  v_exp_f32 v14, v14
  v_exp_f32 v15, v15
  v_exp_f32 v16, v16
  v_exp_f32 v17, v17
  v_exp_f32 v18, v18
  v_exp_f32 v19, v19
  v_cvt_pk_bf16_f32 v20, v12, v13
  v_cvt_pk_bf16_f32 v21, v14, v15
  v_cvt_pk_bf16_f32 v22, v16, v17
  v_cvt_pk_bf16_f32 v23, v18, v19
  v_add_f32 v24, v12, v13
  v_add_f32 v25, v14, v15
  v_add_f32 v26, v16, v17
  v_add_f32 v27, v18, v19
  v_add_f32 v24, v24, v25
  v_add_f32 v26, v26, v27
  v_add_f32 v24, v24, v26
  v_add_f32 v7, v7, v24
  s_waitcnt vmcnt(16)
  v_perm_b32 v76, v212, v208, s25
  v_perm_b32 v80, v212, v208, s26
  v_perm_b32 v77, v220, v216, s25
  v_perm_b32 v81, v220, v216, s26
  v_perm_b32 v78, v228, v224, s25
  v_perm_b32 v82, v228, v224, s26
  v_perm_b32 v79, v236, v232, s25
  v_perm_b32 v83, v236, v232, s26
  v_perm_b32 v84, v213, v209, s25
  v_perm_b32 v88, v213, v209, s26
  v_perm_b32 v85, v221, v217, s25
  v_perm_b32 v89, v221, v217, s26
  v_perm_b32 v86, v229, v225, s25
  v_perm_b32 v90, v229, v225, s26
  v_perm_b32 v87, v237, v233, s25
  v_perm_b32 v91, v237, v233, s26
  v_perm_b32 v92, v214, v210, s25
  v_perm_b32 v96, v214, v210, s26
  v_perm_b32 v93, v222, v218, s25
  v_perm_b32 v97, v222, v218, s26
  v_perm_b32 v94, v230, v226, s25
  v_perm_b32 v98, v230, v226, s26
  v_perm_b32 v95, v238, v234, s25
  v_perm_b32 v99, v238, v234, s26
  v_perm_b32 v100, v215, v211, s25
  v_perm_b32 v104, v215, v211, s26
  v_perm_b32 v101, v223, v219, s25
  v_perm_b32 v105, v223, v219, s26
  v_perm_b32 v102, v231, v227, s25
  v_perm_b32 v106, v231, v227, s26
  v_perm_b32 v103, v239, v235, s25
  v_perm_b32 v107, v239, v235, s26
  ds_read_b128 v[208:211], v108 offset:8192
  ds_read_b128 v[212:215], v108 offset:9216
  ds_read_b128 v[216:219], v108 offset:10240
  ds_read_b128 v[220:223], v108 offset:11264
  ds_read_b128 v[224:227], v108 offset:12288
  ds_read_b128 v[228:231], v108 offset:13312
  ds_read_b128 v[232:235], v108 offset:14336
  ds_read_b128 v[236:239], v108 offset:15360
  v_mfma_f32_16x16x32_bf16 v[44:47], v[20:23], v[76:79], v[44:47]
  v_mfma_f32_16x16x32_bf16 v[48:51], v[20:23], v[80:83], v[48:51]
  v_mfma_f32_16x16x32_bf16 v[52:55], v[20:23], v[84:87], v[52:55]
  v_mfma_f32_16x16x32_bf16 v[56:59], v[20:23], v[88:91], v[56:59]
  v_mfma_f32_16x16x32_bf16 v[60:63], v[20:23], v[92:95], v[60:63]
  v_mfma_f32_16x16x32_bf16 v[64:67], v[20:23], v[96:99], v[64:67]
  v_mfma_f32_16x16x32_bf16 v[68:71], v[20:23], v[100:103], v[68:71]
  v_mfma_f32_16x16x32_bf16 v[72:75], v[20:23], v[104:107], v[72:75]
  s_setprio 0
  s_waitcnt vmcnt(8)
  v_mfma_f32_16x16x32_bf16 v[12:15], v[112:115], v[28:31], 0
  v_mfma_f32_16x16x32_bf16 v[16:19], v[128:131], v[28:31], 0
  v_mfma_f32_16x16x32_bf16 v[12:15], v[116:119], v[32:35], v[12:15]
  v_mfma_f32_16x16x32_bf16 v[16:19], v[132:135], v[32:35], v[16:19]
  v_mfma_f32_16x16x32_bf16 v[12:15], v[120:123], v[36:39], v[12:15]
  v_mfma_f32_16x16x32_bf16 v[16:19], v[136:139], v[36:39], v[16:19]
  v_mfma_f32_16x16x32_bf16 v[12:15], v[124:127], v[40:43], v[12:15]
  v_mfma_f32_16x16x32_bf16 v[16:19], v[140:143], v[40:43], v[16:19]
  buffer_load_dwordx4 v[112:115], v1, s[8:11], 0 offen offset:0 nt
  buffer_load_dwordx4 v[116:119], v1, s[8:11], 0 offen offset:64 nt
  buffer_load_dwordx4 v[120:123], v1, s[8:11], 0 offen offset:128 nt
  buffer_load_dwordx4 v[124:127], v1, s[8:11], 0 offen offset:192 nt
  buffer_load_dwordx4 v[128:131], v2, s[8:11], 0 offen offset:0 nt
  buffer_load_dwordx4 v[132:135], v2, s[8:11], 0 offen offset:64 nt
  buffer_load_dwordx4 v[136:139], v2, s[8:11], 0 offen offset:128 nt
  buffer_load_dwordx4 v[140:143], v2, s[8:11], 0 offen offset:192 nt
  v_add_u32 v1, s22, v1
  v_add_u32 v2, s22, v2
  v_cvt_pk_bf16_f32 v24, v12, v13
  v_cvt_pk_bf16_f32 v25, v14, v15
  v_cvt_pk_bf16_f32 v26, v16, v17
  v_cvt_pk_bf16_f32 v27, v18, v19
  v_lshlrev_b32 v12, 16, v24
  v_and_b32 v13, 0xffff0000, v24
  v_lshlrev_b32 v14, 16, v25
  v_and_b32 v15, 0xffff0000, v25
  v_lshlrev_b32 v16, 16, v26
  v_and_b32 v17, 0xffff0000, v26
  v_lshlrev_b32 v18, 16, v27
  v_and_b32 v19, 0xffff0000, v27
  v_mul_f32 v12, s28, v12
  v_mul_f32 v13, s28, v13
  v_mul_f32 v14, s28, v14
  v_mul_f32 v15, s28, v15
  v_mul_f32 v16, s28, v16
  v_mul_f32 v17, s28, v17
  v_mul_f32 v18, s28, v18
  v_mul_f32 v19, s28, v19
  v_cvt_pk_bf16_f32 v24, v12, v13
  v_cvt_pk_bf16_f32 v25, v14, v15
  v_cvt_pk_bf16_f32 v26, v16, v17
  v_cvt_pk_bf16_f32 v27, v18, v19
  v_lshlrev_b32 v12, 16, v24
  v_and_b32 v13, 0xffff0000, v24
  v_lshlrev_b32 v14, 16, v25
  v_and_b32 v15, 0xffff0000, v25
  v_lshlrev_b32 v16, 16, v26
  v_and_b32 v17, 0xffff0000, v26
  v_lshlrev_b32 v18, 16, v27
  v_and_b32 v19, 0xffff0000, v27
  v_max3_f32 v9, v5, v12, v13
  v_max3_f32 v9, v9, v14, v15
  v_max3_f32 v9, v9, v16, v17
  v_max3_f32 v9, v9, v18, v19
  v_cmp_gt_f32 vcc, v9, v5
  s_cbranch_vccz sequential_preLN__gqa_block_cached__mixer_token_mlp__decode_kernel_skip6
  v_mov_b32 v11, v9
  s_nop 1
  v_permlane16_swap_b32 v9, v11
  v_max_f32 v9, v9, v11
  v_mov_b32 v11, v9
  s_nop 1
  v_permlane32_swap_b32 v9, v11
  v_max_f32 v9, v9, v11
  v_sub_f32 v10, v5, v9
  v_mul_f32 v10, s27, v10
  v_exp_f32 v10, v10
  v_mov_b32 v5, v9
  v_mul_f32_e64 v6, -v9, s27
  v_mul_f32 v7, v7, v10
  v_mov_b32_dpp v8, v10 row_newbcast:0 row_mask:0x1 bank_mask:0xf
  v_mov_b32_dpp v8, v10 row_newbcast:4 row_mask:0x2 bank_mask:0xf
  v_mov_b32_dpp v8, v10 row_newbcast:8 row_mask:0x4 bank_mask:0xf
  v_mov_b32_dpp v8, v10 row_newbcast:12 row_mask:0x8 bank_mask:0xf
  v_mul_f32 v44, v8, v44
  v_mul_f32 v48, v8, v48
  v_mul_f32 v52, v8, v52
  v_mul_f32 v56, v8, v56
  v_mul_f32 v60, v8, v60
  v_mul_f32 v64, v8, v64
  v_mul_f32 v68, v8, v68
  v_mul_f32 v72, v8, v72
sequential_preLN__gqa_block_cached__mixer_token_mlp__decode_kernel_skip6:
  v_fma_f32 v12, v12, s27, v6
  v_fma_f32 v13, v13, s27, v6
  v_fma_f32 v14, v14, s27, v6
  v_fma_f32 v15, v15, s27, v6
  v_fma_f32 v16, v16, s27, v6
  v_fma_f32 v17, v17, s27, v6
  v_fma_f32 v18, v18, s27, v6
  v_fma_f32 v19, v19, s27, v6
  v_exp_f32 v12, v12
  v_exp_f32 v13, v13
  v_exp_f32 v14, v14
  v_exp_f32 v15, v15
  v_exp_f32 v16, v16
  v_exp_f32 v17, v17
  v_exp_f32 v18, v18
  v_exp_f32 v19, v19
  v_cvt_pk_bf16_f32 v20, v12, v13
  v_cvt_pk_bf16_f32 v21, v14, v15
  v_cvt_pk_bf16_f32 v22, v16, v17
  v_cvt_pk_bf16_f32 v23, v18, v19
  v_add_f32 v24, v12, v13
  v_add_f32 v25, v14, v15
  v_add_f32 v26, v16, v17
  v_add_f32 v27, v18, v19
  v_add_f32 v24, v24, v25
  v_add_f32 v26, v26, v27
  v_add_f32 v24, v24, v26
  v_add_f32 v7, v7, v24
  s_waitcnt vmcnt(8)
  v_perm_b32 v76, v148, v144, s25
  v_perm_b32 v80, v148, v144, s26
  v_perm_b32 v77, v156, v152, s25
  v_perm_b32 v81, v156, v152, s26
  v_perm_b32 v78, v164, v160, s25
  v_perm_b32 v82, v164, v160, s26
  v_perm_b32 v79, v172, v168, s25
  v_perm_b32 v83, v172, v168, s26
  v_perm_b32 v84, v149, v145, s25
  v_perm_b32 v88, v149, v145, s26
  v_perm_b32 v85, v157, v153, s25
  v_perm_b32 v89, v157, v153, s26
  v_perm_b32 v86, v165, v161, s25
  v_perm_b32 v90, v165, v161, s26
  v_perm_b32 v87, v173, v169, s25
  v_perm_b32 v91, v173, v169, s26
  v_perm_b32 v92, v150, v146, s25
  v_perm_b32 v96, v150, v146, s26
  v_perm_b32 v93, v158, v154, s25
  v_perm_b32 v97, v158, v154, s26
  v_perm_b32 v94, v166, v162, s25
  v_perm_b32 v98, v166, v162, s26
  v_perm_b32 v95, v174, v170, s25
  v_perm_b32 v99, v174, v170, s26
  v_perm_b32 v100, v151, v147, s25
  v_perm_b32 v104, v151, v147, s26
  v_perm_b32 v101, v159, v155, s25
  v_perm_b32 v105, v159, v155, s26
  v_perm_b32 v102, v167, v163, s25
  v_perm_b32 v106, v167, v163, s26
  v_perm_b32 v103, v175, v171, s25
  v_perm_b32 v107, v175, v171, s26
  buffer_load_dwordx4 v[144:147], v3, s[12:15], 0 offen offset:0 nt
  buffer_load_dwordx4 v[148:151], v3, s[12:15], 0 offen offset:1024 nt
  buffer_load_dwordx4 v[152:155], v3, s[12:15], 0 offen offset:2048 nt
  buffer_load_dwordx4 v[156:159], v3, s[12:15], 0 offen offset:3072 nt
  buffer_load_dwordx4 v[160:163], v4, s[12:15], 0 offen offset:0 nt
  buffer_load_dwordx4 v[164:167], v4, s[12:15], 0 offen offset:1024 nt
  buffer_load_dwordx4 v[168:171], v4, s[12:15], 0 offen offset:2048 nt
  buffer_load_dwordx4 v[172:175], v4, s[12:15], 0 offen offset:3072 nt
  v_add_u32 v3, s22, v3
  v_add_u32 v4, s22, v4
  v_mfma_f32_16x16x32_bf16 v[44:47], v[20:23], v[76:79], v[44:47]
  v_mfma_f32_16x16x32_bf16 v[48:51], v[20:23], v[80:83], v[48:51]
  v_mfma_f32_16x16x32_bf16 v[52:55], v[20:23], v[84:87], v[52:55]
  v_mfma_f32_16x16x32_bf16 v[56:59], v[20:23], v[88:91], v[56:59]
  v_mfma_f32_16x16x32_bf16 v[60:63], v[20:23], v[92:95], v[60:63]
  v_mfma_f32_16x16x32_bf16 v[64:67], v[20:23], v[96:99], v[64:67]
  v_mfma_f32_16x16x32_bf16 v[68:71], v[20:23], v[100:103], v[68:71]
  v_mfma_f32_16x16x32_bf16 v[72:75], v[20:23], v[104:107], v[72:75]
  s_waitcnt lgkmcnt(0)
  v_mfma_f32_16x16x32_bf16 v[12:15], v[176:179], v[28:31], 0
  v_mfma_f32_16x16x32_bf16 v[16:19], v[192:195], v[28:31], 0
  v_mfma_f32_16x16x32_bf16 v[12:15], v[180:183], v[32:35], v[12:15]
  v_mfma_f32_16x16x32_bf16 v[16:19], v[196:199], v[32:35], v[16:19]
  v_mfma_f32_16x16x32_bf16 v[12:15], v[184:187], v[36:39], v[12:15]
  v_mfma_f32_16x16x32_bf16 v[16:19], v[200:203], v[36:39], v[16:19]
  v_mfma_f32_16x16x32_bf16 v[12:15], v[188:191], v[40:43], v[12:15]
  v_mfma_f32_16x16x32_bf16 v[16:19], v[204:207], v[40:43], v[16:19]
  s_nop 6
  v_cvt_pk_bf16_f32 v24, v12, v13
  v_cvt_pk_bf16_f32 v25, v14, v15
  v_cvt_pk_bf16_f32 v26, v16, v17
  v_cvt_pk_bf16_f32 v27, v18, v19
  v_lshlrev_b32 v12, 16, v24
  v_and_b32 v13, 0xffff0000, v24
  v_lshlrev_b32 v14, 16, v25
  v_and_b32 v15, 0xffff0000, v25
  v_lshlrev_b32 v16, 16, v26
  v_and_b32 v17, 0xffff0000, v26
  v_lshlrev_b32 v18, 16, v27
  v_and_b32 v19, 0xffff0000, v27
  v_mul_f32 v12, s28, v12
  v_mul_f32 v13, s28, v13
  v_mul_f32 v14, s28, v14
  v_mul_f32 v15, s28, v15
  v_mul_f32 v16, s28, v16
  v_mul_f32 v17, s28, v17
  v_mul_f32 v18, s28, v18
  v_mul_f32 v19, s28, v19
  v_cvt_pk_bf16_f32 v24, v12, v13
  v_cvt_pk_bf16_f32 v25, v14, v15
  v_cvt_pk_bf16_f32 v26, v16, v17
  v_cvt_pk_bf16_f32 v27, v18, v19
  v_lshlrev_b32 v12, 16, v24
  v_and_b32 v13, 0xffff0000, v24
  v_lshlrev_b32 v14, 16, v25
  v_and_b32 v15, 0xffff0000, v25
  v_lshlrev_b32 v16, 16, v26
  v_and_b32 v17, 0xffff0000, v26
  v_lshlrev_b32 v18, 16, v27
  v_and_b32 v19, 0xffff0000, v27
  v_max3_f32 v9, v5, v12, v13
  v_max3_f32 v9, v9, v14, v15
  v_max3_f32 v9, v9, v16, v17
  v_max3_f32 v9, v9, v18, v19
  v_cmp_gt_f32 vcc, v9, v5
  s_cbranch_vccz sequential_preLN__gqa_block_cached__mixer_token_mlp__decode_kernel_skip7
  v_mov_b32 v11, v9
  s_nop 1
  v_permlane16_swap_b32 v9, v11
  v_max_f32 v9, v9, v11
  v_mov_b32 v11, v9
  s_nop 1
  v_permlane32_swap_b32 v9, v11
  v_max_f32 v9, v9, v11
  v_sub_f32 v10, v5, v9
  v_mul_f32 v10, s27, v10
  v_exp_f32 v10, v10
  v_mov_b32 v5, v9
  v_mul_f32_e64 v6, -v9, s27
  v_mul_f32 v7, v7, v10
  v_mov_b32_dpp v8, v10 row_newbcast:0 row_mask:0x1 bank_mask:0xf
  v_mov_b32_dpp v8, v10 row_newbcast:4 row_mask:0x2 bank_mask:0xf
  v_mov_b32_dpp v8, v10 row_newbcast:8 row_mask:0x4 bank_mask:0xf
  v_mov_b32_dpp v8, v10 row_newbcast:12 row_mask:0x8 bank_mask:0xf
  v_mul_f32 v44, v8, v44
  v_mul_f32 v48, v8, v48
  v_mul_f32 v52, v8, v52
  v_mul_f32 v56, v8, v56
  v_mul_f32 v60, v8, v60
  v_mul_f32 v64, v8, v64
  v_mul_f32 v68, v8, v68
  v_mul_f32 v72, v8, v72
sequential_preLN__gqa_block_cached__mixer_token_mlp__decode_kernel_skip7:
  v_fma_f32 v12, v12, s27, v6
  v_fma_f32 v13, v13, s27, v6
  v_fma_f32 v14, v14, s27, v6
  v_fma_f32 v15, v15, s27, v6
  v_fma_f32 v16, v16, s27, v6
  v_fma_f32 v17, v17, s27, v6
  v_fma_f32 v18, v18, s27, v6
  v_fma_f32 v19, v19, s27, v6
  v_exp_f32 v12, v12
  v_exp_f32 v13, v13
  v_exp_f32 v14, v14
  v_exp_f32 v15, v15
  v_exp_f32 v16, v16
  v_exp_f32 v17, v17
  v_exp_f32 v18, v18
  v_exp_f32 v19, v19
  v_cvt_pk_bf16_f32 v20, v12, v13
  v_cvt_pk_bf16_f32 v21, v14, v15
  v_cvt_pk_bf16_f32 v22, v16, v17
  v_cvt_pk_bf16_f32 v23, v18, v19
  v_add_f32 v24, v12, v13
  v_add_f32 v25, v14, v15
  v_add_f32 v26, v16, v17
  v_add_f32 v27, v18, v19
  v_add_f32 v24, v24, v25
  v_add_f32 v26, v26, v27
  v_add_f32 v24, v24, v26
  v_add_f32 v7, v7, v24
  v_perm_b32 v76, v212, v208, s25
  v_perm_b32 v80, v212, v208, s26
  v_perm_b32 v77, v220, v216, s25
  v_perm_b32 v81, v220, v216, s26
  v_perm_b32 v78, v228, v224, s25
  v_perm_b32 v82, v228, v224, s26
  v_perm_b32 v79, v236, v232, s25
  v_perm_b32 v83, v236, v232, s26
  v_perm_b32 v84, v213, v209, s25
  v_perm_b32 v88, v213, v209, s26
  v_perm_b32 v85, v221, v217, s25
  v_perm_b32 v89, v221, v217, s26
  v_perm_b32 v86, v229, v225, s25
  v_perm_b32 v90, v229, v225, s26
  v_perm_b32 v87, v237, v233, s25
  v_perm_b32 v91, v237, v233, s26
  v_perm_b32 v92, v214, v210, s25
  v_perm_b32 v96, v214, v210, s26
  v_perm_b32 v93, v222, v218, s25
  v_perm_b32 v97, v222, v218, s26
  v_perm_b32 v94, v230, v226, s25
  v_perm_b32 v98, v230, v226, s26
  v_perm_b32 v95, v238, v234, s25
  v_perm_b32 v99, v238, v234, s26
  v_perm_b32 v100, v215, v211, s25
  v_perm_b32 v104, v215, v211, s26
  v_perm_b32 v101, v223, v219, s25
  v_perm_b32 v105, v223, v219, s26
  v_perm_b32 v102, v231, v227, s25
  v_perm_b32 v106, v231, v227, s26
  v_perm_b32 v103, v239, v235, s25
  v_perm_b32 v107, v239, v235, s26
  v_mfma_f32_16x16x32_bf16 v[44:47], v[20:23], v[76:79], v[44:47]
  v_mfma_f32_16x16x32_bf16 v[48:51], v[20:23], v[80:83], v[48:51]
  v_mfma_f32_16x16x32_bf16 v[52:55], v[20:23], v[84:87], v[52:55]
  v_mfma_f32_16x16x32_bf16 v[56:59], v[20:23], v[88:91], v[56:59]
  v_mfma_f32_16x16x32_bf16 v[60:63], v[20:23], v[92:95], v[60:63]
  v_mfma_f32_16x16x32_bf16 v[64:67], v[20:23], v[96:99], v[64:67]
  v_mfma_f32_16x16x32_bf16 v[68:71], v[20:23], v[100:103], v[68:71]
  v_mfma_f32_16x16x32_bf16 v[72:75], v[20:23], v[104:107], v[72:75]
  s_nop 7
sequential_preLN__gqa_block_cached__mixer_token_mlp__decode_kernel_last:
  s_waitcnt vmcnt(8)
  v_mfma_f32_16x16x32_bf16 v[12:15], v[112:115], v[28:31], 0
  v_mfma_f32_16x16x32_bf16 v[16:19], v[128:131], v[28:31], 0
  v_mfma_f32_16x16x32_bf16 v[12:15], v[116:119], v[32:35], v[12:15]
  v_mfma_f32_16x16x32_bf16 v[16:19], v[132:135], v[32:35], v[16:19]
  v_mfma_f32_16x16x32_bf16 v[12:15], v[120:123], v[36:39], v[12:15]
  v_mfma_f32_16x16x32_bf16 v[16:19], v[136:139], v[36:39], v[16:19]
  v_mfma_f32_16x16x32_bf16 v[12:15], v[124:127], v[40:43], v[12:15]
  v_mfma_f32_16x16x32_bf16 v[16:19], v[140:143], v[40:43], v[16:19]
  s_nop 6
  v_cvt_pk_bf16_f32 v24, v12, v13
  v_cvt_pk_bf16_f32 v25, v14, v15
  v_cvt_pk_bf16_f32 v26, v16, v17
  v_cvt_pk_bf16_f32 v27, v18, v19
  v_lshlrev_b32 v12, 16, v24
  v_and_b32 v13, 0xffff0000, v24
  v_lshlrev_b32 v14, 16, v25
  v_and_b32 v15, 0xffff0000, v25
  v_lshlrev_b32 v16, 16, v26
  v_and_b32 v17, 0xffff0000, v26
  v_lshlrev_b32 v18, 16, v27
  v_and_b32 v19, 0xffff0000, v27
  v_mul_f32 v12, s28, v12
  v_mul_f32 v13, s28, v13
  v_mul_f32 v14, s28, v14
  v_mul_f32 v15, s28, v15
  v_mul_f32 v16, s28, v16
  v_mul_f32 v17, s28, v17
  v_mul_f32 v18, s28, v18
  v_mul_f32 v19, s28, v19
  v_cvt_pk_bf16_f32 v24, v12, v13
  v_cvt_pk_bf16_f32 v25, v14, v15
  v_cvt_pk_bf16_f32 v26, v16, v17
  v_cvt_pk_bf16_f32 v27, v18, v19
  v_lshlrev_b32 v12, 16, v24
  v_and_b32 v13, 0xffff0000, v24
  v_lshlrev_b32 v14, 16, v25
  v_and_b32 v15, 0xffff0000, v25
  v_lshlrev_b32 v16, 16, v26
  v_and_b32 v17, 0xffff0000, v26
  v_lshlrev_b32 v18, 16, v27
  v_and_b32 v19, 0xffff0000, v27
  v_max3_f32 v9, v5, v12, v13
  v_max3_f32 v9, v9, v14, v15
  v_max3_f32 v9, v9, v16, v17
  v_max3_f32 v9, v9, v18, v19
  v_cmp_gt_f32 vcc, v9, v5
  s_cbranch_vccz sequential_preLN__gqa_block_cached__mixer_token_mlp__decode_kernel_skip8
  v_mov_b32 v11, v9
  s_nop 1
  v_permlane16_swap_b32 v9, v11
  v_max_f32 v9, v9, v11
  v_mov_b32 v11, v9
  s_nop 1
  v_permlane32_swap_b32 v9, v11
  v_max_f32 v9, v9, v11
  v_sub_f32 v10, v5, v9
  v_mul_f32 v10, s27, v10
  v_exp_f32 v10, v10
  v_mov_b32 v5, v9
  v_mul_f32_e64 v6, -v9, s27
  v_mul_f32 v7, v7, v10
  v_mov_b32_dpp v8, v10 row_newbcast:0 row_mask:0x1 bank_mask:0xf
  v_mov_b32_dpp v8, v10 row_newbcast:4 row_mask:0x2 bank_mask:0xf
  v_mov_b32_dpp v8, v10 row_newbcast:8 row_mask:0x4 bank_mask:0xf
  v_mov_b32_dpp v8, v10 row_newbcast:12 row_mask:0x8 bank_mask:0xf
  v_mul_f32 v44, v8, v44
  v_mul_f32 v48, v8, v48
  v_mul_f32 v52, v8, v52
  v_mul_f32 v56, v8, v56
  v_mul_f32 v60, v8, v60
  v_mul_f32 v64, v8, v64
  v_mul_f32 v68, v8, v68
  v_mul_f32 v72, v8, v72
sequential_preLN__gqa_block_cached__mixer_token_mlp__decode_kernel_skip8:
  v_fma_f32 v12, v12, s27, v6
  v_fma_f32 v13, v13, s27, v6
  v_fma_f32 v14, v14, s27, v6
  v_fma_f32 v15, v15, s27, v6
  v_fma_f32 v16, v16, s27, v6
  v_fma_f32 v17, v17, s27, v6
  v_fma_f32 v18, v18, s27, v6
  v_fma_f32 v19, v19, s27, v6
  v_exp_f32 v12, v12
  v_exp_f32 v13, v13
  v_exp_f32 v14, v14
  v_exp_f32 v15, v15
  v_exp_f32 v16, v16
  v_exp_f32 v17, v17
  v_exp_f32 v18, v18
  v_exp_f32 v19, v19
  v_cvt_pk_bf16_f32 v20, v12, v13
  v_cvt_pk_bf16_f32 v21, v14, v15
  v_cvt_pk_bf16_f32 v22, v16, v17
  v_cvt_pk_bf16_f32 v23, v18, v19
  v_add_f32 v24, v12, v13
  v_add_f32 v25, v14, v15
  v_add_f32 v26, v16, v17
  v_add_f32 v27, v18, v19
  v_add_f32 v24, v24, v25
  v_add_f32 v26, v26, v27
  v_add_f32 v24, v24, v26
  v_add_f32 v7, v7, v24
  s_waitcnt vmcnt(0)
  v_perm_b32 v76, v148, v144, s25
  v_perm_b32 v80, v148, v144, s26
  v_perm_b32 v77, v156, v152, s25
  v_perm_b32 v81, v156, v152, s26
  v_perm_b32 v78, v164, v160, s25
  v_perm_b32 v82, v164, v160, s26
  v_perm_b32 v79, v172, v168, s25
  v_perm_b32 v83, v172, v168, s26
  v_perm_b32 v84, v149, v145, s25
  v_perm_b32 v88, v149, v145, s26
  v_perm_b32 v85, v157, v153, s25
  v_perm_b32 v89, v157, v153, s26
  v_perm_b32 v86, v165, v161, s25
  v_perm_b32 v90, v165, v161, s26
  v_perm_b32 v87, v173, v169, s25
  v_perm_b32 v91, v173, v169, s26
  v_perm_b32 v92, v150, v146, s25
  v_perm_b32 v96, v150, v146, s26
  v_perm_b32 v93, v158, v154, s25
  v_perm_b32 v97, v158, v154, s26
  v_perm_b32 v94, v166, v162, s25
  v_perm_b32 v98, v166, v162, s26
  v_perm_b32 v95, v174, v170, s25
  v_perm_b32 v99, v174, v170, s26
  v_perm_b32 v100, v151, v147, s25
  v_perm_b32 v104, v151, v147, s26
  v_perm_b32 v101, v159, v155, s25
  v_perm_b32 v105, v159, v155, s26
  v_perm_b32 v102, v167, v163, s25
  v_perm_b32 v106, v167, v163, s26
  v_perm_b32 v103, v175, v171, s25
  v_perm_b32 v107, v175, v171, s26
  v_mfma_f32_16x16x32_bf16 v[44:47], v[20:23], v[76:79], v[44:47]
  v_mfma_f32_16x16x32_bf16 v[48:51], v[20:23], v[80:83], v[48:51]
  v_mfma_f32_16x16x32_bf16 v[52:55], v[20:23], v[84:87], v[52:55]
  v_mfma_f32_16x16x32_bf16 v[56:59], v[20:23], v[88:91], v[56:59]
  v_mfma_f32_16x16x32_bf16 v[60:63], v[20:23], v[92:95], v[60:63]
  v_mfma_f32_16x16x32_bf16 v[64:67], v[20:23], v[96:99], v[64:67]
  v_mfma_f32_16x16x32_bf16 v[68:71], v[20:23], v[100:103], v[68:71]
  v_mfma_f32_16x16x32_bf16 v[72:75], v[20:23], v[104:107], v[72:75]
  s_nop 7
  s_cmp_eq_u32 s3, 0
  s_cbranch_scc1 sequential_preLN__gqa_block_cached__mixer_token_mlp__decode_kernel_tg0
sequential_preLN__gqa_block_cached__mixer_token_mlp__decode_kernel_tgd:
  v_mov_b32 v11, v7
  s_nop 1
  v_permlane16_swap_b32 v7, v11
  v_add_f32 v7, v7, v11
  s_lshl_b32 s29, s3, 11
  v_lshl_add_u32 v24, v0, 2, s29
  v_mov_b32 v11, v7
  s_nop 1
  v_permlane32_swap_b32 v7, v11
  v_add_f32 v13, v7, v11
  s_lshl_b32 s29, s3, 3
  v_lshl_add_u32 v10, v0, 4, s29
  v_mul_f32 v12, s27, v5
  s_mov_b64 exec, 0x1111
  ds_write_b64 v10, v[12:13] offset:2304
  s_mov_b64 exec, -1
  ds_write2st64_b32 v24, v44, v48 offset0:31 offset1:32
  ds_write2st64_b32 v24, v52, v56 offset0:33 offset1:34
  ds_write2st64_b32 v24, v60, v64 offset0:35 offset1:36
  ds_write2st64_b32 v24, v68, v72 offset0:37 offset1:38
  v_lshrrev_b32 v11, 4, v0
  v_lshlrev_b32 v11, 6, v11
  s_lshl_b32 s30, s3, 8
  v_lshl_add_u32 v10, v0, 2, s30
  s_lshl_b32 s30, s20, 16
  s_lshl_b32 s34, s21, 10
  s_add_u32 s30, s30, s34
  s_lshl_b32 s34, s3, 7
  s_add_u32 s30, s30, s34
  s_add_u32 s30, s30, 262144
  v_lshrrev_b32 v25, 5, v0
  v_lshlrev_b32 v25, 15, v25
  v_and_b32 v26, 31, v0
  v_lshl_add_u32 v25, v26, 2, v25
  v_add_u32 v25, s30, v25
  s_lshl_b32 s30, s20, 10
  s_lshl_b32 s34, s21, 3
  s_add_u32 s30, s30, s34
  s_add_u32 s30, s30, 786432
  v_lshl_add_u32 v20, v0, 4, s30
  s_mov_b32 s6, 0x00010001
  s_mov_b32 s7, 0x00010001
  s_waitcnt lgkmcnt(0)
  s_barrier
  ds_read_b128 v[76:79], v11 offset:2304
  ds_read_b128 v[80:83], v11 offset:2320
  ds_read_b128 v[84:87], v11 offset:2336
  ds_read_b128 v[88:91], v11 offset:2352
  ds_read2st64_b32 v[92:93], v10 offset0:31 offset1:39
  ds_read2st64_b32 v[94:95], v10 offset0:47 offset1:55
  ds_read2st64_b32 v[96:97], v10 offset0:63 offset1:71
  ds_read2st64_b32 v[98:99], v10 offset0:79 offset1:87
  s_and_b32 s33, s21, 1
  s_lshl_b32 s29, s20, 10
  s_lshl_b32 s30, s33, 9
  s_add_u32 s29, s29, s30
  s_add_u32 s29, s29, 786432
  v_lshl_add_u32 v112, v26, 4, s29
  s_lshl_b32 s29, s20, 16
  s_lshl_b32 s30, s33, 15
  s_add_u32 s29, s29, s30
  s_lshl_b32 s30, s3, 12
  s_add_u32 s29, s29, s30
  s_add_u32 s29, s29, 262144
  v_lshl_add_u32 v113, v0, 4, s29
  s_waitcnt lgkmcnt(4)
  v_max3_f32 v12, v76, v78, v80
  v_max3_f32 v24, v82, v84, v86
  v_max3_f32 v12, v12, v88, v90
  v_max_f32 v12, v12, v24
  v_sub_f32 v76, v76, v12
  v_sub_f32 v78, v78, v12
  v_sub_f32 v80, v80, v12
  v_sub_f32 v82, v82, v12
  v_sub_f32 v84, v84, v12
  v_sub_f32 v86, v86, v12
  v_sub_f32 v88, v88, v12
  v_sub_f32 v90, v90, v12
  v_exp_f32 v76, v76
  v_exp_f32 v78, v78
  v_exp_f32 v80, v80
  v_exp_f32 v82, v82
  v_exp_f32 v84, v84
  v_exp_f32 v86, v86
  v_exp_f32 v88, v88
  v_exp_f32 v90, v90
  s_waitcnt lgkmcnt(0)
  v_mul_f32 v14, v76, v92
  v_mul_f32 v15, v78, v93
  v_fmac_f32 v14, v80, v94
  v_fmac_f32 v15, v82, v95
  v_fmac_f32 v14, v84, v96
  v_fmac_f32 v15, v86, v97
  v_fmac_f32 v14, v88, v98
  v_fmac_f32 v15, v90, v99
  v_add_f32 v14, v14, v15
  v_min_u32 v14, -2, v14
  s_cmp_eq_u32 s62, 1
  s_cbranch_scc1 sequential_preLN__gqa_block_cached__mixer_token_mlp__decode_kernel_soa
  global_store_dword v25, v14, s[46:47] sc1
  s_branch sequential_preLN__gqa_block_cached__mixer_token_mlp__decode_kernel_sob
sequential_preLN__gqa_block_cached__mixer_token_mlp__decode_kernel_soa:
  global_store_dword v25, v14, s[46:47]
sequential_preLN__gqa_block_cached__mixer_token_mlp__decode_kernel_sob:
  s_cmp_lg_u32 s3, 0
  s_cbranch_scc1 sequential_preLN__gqa_block_cached__mixer_token_mlp__decode_kernel_noml
  v_mul_f32 v13, v76, v77
  v_mul_f32 v15, v78, v79
  v_fmac_f32 v13, v80, v81
  v_fmac_f32 v15, v82, v83
  v_fmac_f32 v13, v84, v85
  v_fmac_f32 v15, v86, v87
  v_fmac_f32 v13, v88, v89
  v_fmac_f32 v15, v90, v91
  v_add_f32 v13, v13, v15
  v_min_u32 v12, -2, v12
  v_min_u32 v13, -2, v13
  s_mov_b64 exec, s[6:7]
  s_cmp_eq_u32 s62, 1
  s_cbranch_scc1 sequential_preLN__gqa_block_cached__mixer_token_mlp__decode_kernel_sma
  global_store_dwordx2 v20, v[12:13], s[46:47] sc1
  s_branch sequential_preLN__gqa_block_cached__mixer_token_mlp__decode_kernel_smb
sequential_preLN__gqa_block_cached__mixer_token_mlp__decode_kernel_sma:
  global_store_dwordx2 v20, v[12:13], s[46:47]
sequential_preLN__gqa_block_cached__mixer_token_mlp__decode_kernel_smb:
  s_mov_b64 exec, -1
sequential_preLN__gqa_block_cached__mixer_token_mlp__decode_kernel_noml:
  s_mov_b32 s30, 0
  s_mov_b32 s31, 0
  s_lshl_b32 s29, s3, 8
  v_lshl_add_u32 v25, v26, 3, s29
  v_bfe_u32 v27, v0, 2, 1
  s_lshl_b32 s34, s3, 4
  s_add_u32 s29, s29, s34
  v_lshl_add_u32 v27, v27, 7, s29
sequential_preLN__gqa_block_cached__mixer_token_mlp__decode_kernel_p2:
  global_load_dwordx4 v[144:147], v112, s[46:47] sc1
  s_cmp_eq_u32 s31, 1
  s_cbranch_scc1 sequential_preLN__gqa_block_cached__mixer_token_mlp__decode_kernel_p2m
  global_load_dwordx4 v[176:179], v113, s[46:47] offset:0 sc1
  global_load_dwordx4 v[180:183], v113, s[46:47] offset:1024 sc1
  global_load_dwordx4 v[184:187], v113, s[46:47] offset:2048 sc1
  global_load_dwordx4 v[188:191], v113, s[46:47] offset:3072 sc1
  s_waitcnt vmcnt(0)
  v_max3_u32 v148, v176, v177, v178
  v_max3_u32 v149, v179, v180, v181
  v_max3_u32 v148, v148, v182, v183
  v_max3_u32 v149, v149, v184, v185
  v_max3_u32 v148, v148, v186, v187
  v_max3_u32 v149, v149, v188, v189
  v_max3_u32 v148, v148, v190, v191
  v_max_u32 v148, v148, v149
  v_cmp_eq_u32 vcc, -1, v148
  s_cmp_eq_u64 vcc, 0
  s_cselect_b32 s31, 1, 0
sequential_preLN__gqa_block_cached__mixer_token_mlp__decode_kernel_p2m:
  s_add_u32 s30, s30, 1
  s_waitcnt vmcnt(0)
  v_max3_u32 v148, v144, v145, v146
  v_max_u32 v148, v148, v147
  v_cmp_eq_u32 vcc, -1, v148
  s_cmp_gt_u32 s30, 400000
  s_cbranch_scc1 sequential_preLN__gqa_block_cached__mixer_token_mlp__decode_kernel_p2d
  s_cbranch_vccnz sequential_preLN__gqa_block_cached__mixer_token_mlp__decode_kernel_p2s
  s_cmp_eq_u32 s31, 1
  s_cbranch_scc1 sequential_preLN__gqa_block_cached__mixer_token_mlp__decode_kernel_p2d
sequential_preLN__gqa_block_cached__mixer_token_mlp__decode_kernel_p2s:
  s_branch sequential_preLN__gqa_block_cached__mixer_token_mlp__decode_kernel_p2
sequential_preLN__gqa_block_cached__mixer_token_mlp__decode_kernel_p2d:
  v_max_f32 v24, v144, v146
  s_nop 1
  v_max_f32_dpp v24, v24, v24 quad_perm:[1,0,3,2] row_mask:0xf bank_mask:0xf
  s_nop 1
  v_max_f32_dpp v24, v24, v24 quad_perm:[2,3,0,1] row_mask:0xf bank_mask:0xf
  s_nop 1
  v_max_f32_dpp v24, v24, v24 row_half_mirror row_mask:0xf bank_mask:0xf
  s_nop 1
  v_max_f32_dpp v24, v24, v24 row_mirror row_mask:0xf bank_mask:0xf
  v_sub_f32 v148, v144, v24
  v_sub_f32 v149, v146, v24
  v_exp_f32 v148, v148
  v_exp_f32 v149, v149
  s_nop 0
  ds_write_b64 v25, v[148:149] offset:2560
  v_mul_f32 v24, v148, v145
  v_fmac_f32 v24, v149, v147
  s_waitcnt lgkmcnt(0)
  ds_read_b128 v[160:163], v27 offset:2560
  v_add_f32_dpp v24, v24, v24 quad_perm:[1,0,3,2] row_mask:0xf bank_mask:0xf
  s_nop 1
  v_add_f32_dpp v24, v24, v24 quad_perm:[2,3,0,1] row_mask:0xf bank_mask:0xf
  s_nop 1
  v_add_f32_dpp v24, v24, v24 row_half_mirror row_mask:0xf bank_mask:0xf
  s_nop 1
  v_add_f32_dpp v24, v24, v24 row_mirror row_mask:0xf bank_mask:0xf
  v_rcp_f32 v24, v24
  s_lshl_b32 s34, s3, 10
  v_lshl_add_u32 v25, v0, 4, s34
  v_lshrrev_b32 v27, 2, v0
  s_lshl_b32 s34, s3, 7
  v_lshl_add_u32 v27, v27, 2, s34
  v_readlane_b32 s4, v24, 0
  v_readlane_b32 s5, v24, 16
  s_waitcnt lgkmcnt(0)
  v_mul_f32 v152, v160, v176
  v_mul_f32 v153, v160, v177
  v_mul_f32 v154, v160, v178
  v_mul_f32 v155, v160, v179
  v_fmac_f32 v152, v161, v180
  v_fmac_f32 v153, v161, v181
  v_fmac_f32 v154, v161, v182
  v_fmac_f32 v155, v161, v183
  v_fmac_f32 v152, v162, v184
  v_fmac_f32 v153, v162, v185
  v_fmac_f32 v154, v162, v186
  v_fmac_f32 v155, v162, v187
  v_fmac_f32 v152, v163, v188
  v_fmac_f32 v153, v163, v189
  v_fmac_f32 v154, v163, v190
  v_fmac_f32 v155, v163, v191
  ds_write_b128 v25, v[152:155] offset:24320
  v_lshlrev_b32 v208, 16, v240
  v_and_b32 v209, 0xffff0000, v240
  v_lshlrev_b32 v210, 16, v241
  v_and_b32 v211, 0xffff0000, v241
  v_lshlrev_b32 v212, 16, v242
  v_and_b32 v213, 0xffff0000, v242
  v_lshlrev_b32 v214, 16, v243
  v_and_b32 v215, 0xffff0000, v243
  v_lshlrev_b32 v216, 16, v244
  v_and_b32 v217, 0xffff0000, v244
  v_lshlrev_b32 v218, 16, v245
  v_and_b32 v219, 0xffff0000, v245
  v_lshlrev_b32 v220, 16, v246
  v_and_b32 v221, 0xffff0000, v246
  v_lshlrev_b32 v222, 16, v247
  v_and_b32 v223, 0xffff0000, v247
  v_add_u32 v24, 64, v27
  v_and_b32 v25, 3, v0
  v_lshrrev_b32 v11, 4, v0
  v_lshlrev_b32 v25, 5, v25
  v_lshl_add_u32 v25, v11, 3, v25
  v_add_u32 v25, s34, v25
  s_waitcnt lgkmcnt(0)
  s_barrier
  ds_read2st64_b32 v[168:169], v27 offset0:95 offset1:99
  ds_read2st64_b32 v[170:171], v27 offset0:103 offset1:107
  ds_read2st64_b32 v[172:173], v27 offset0:111 offset1:115
  ds_read2st64_b32 v[174:175], v27 offset0:119 offset1:123
  ds_read2st64_b32 v[176:177], v24 offset0:95 offset1:99
  ds_read2st64_b32 v[178:179], v24 offset0:103 offset1:107
  ds_read2st64_b32 v[180:181], v24 offset0:111 offset1:115
  ds_read2st64_b32 v[182:183], v24 offset0:119 offset1:123
  v_lshlrev_b32 v26, 2, v0
  s_lshl_b32 s29, s20, 12
  s_lshl_b32 s30, s33, 11
  s_add_u32 s29, s29, s30
  s_lshr_b32 s30, s21, 1
  s_lshl_b32 s30, s30, 7
  s_add_u32 s29, s29, s30
  s_add_u32 s29, s29, 851968
  v_add_u32 v27, s29, v26
  s_mov_b32 s6, 0x000f000f
  s_mov_b32 s7, 0x000f000f
  s_waitcnt lgkmcnt(4)
  v_add_f32 v168, v168, v169
  v_add_f32 v170, v170, v171
  v_add_f32 v172, v172, v173
  v_add_f32 v174, v174, v175
  v_add_f32 v168, v168, v170
  v_add_f32 v172, v172, v174
  s_waitcnt lgkmcnt(0)
  v_add_f32 v176, v176, v177
  v_add_f32 v178, v178, v179
  v_add_f32 v180, v180, v181
  v_add_f32 v182, v182, v183
  v_add_f32 v176, v176, v178
  v_add_f32 v180, v180, v182
  v_add_f32 v168, v168, v172
  v_add_f32 v169, v176, v180
  v_mul_f32 v168, s4, v168
  v_mul_f32 v169, s5, v169
  v_cvt_pk_bf16_f32 v24, v168, v169
  v_lshlrev_b32 v168, 16, v24
  v_and_b32 v169, 0xffff0000, v24
  v_mul_f32 v208, v168, v208
  v_mul_f32 v209, v168, v209
  v_mul_f32 v210, v168, v210
  v_mul_f32 v211, v168, v211
  v_mul_f32 v212, v168, v212
  v_mul_f32 v213, v168, v213
  v_mul_f32 v214, v168, v214
  v_mul_f32 v215, v168, v215
  v_fmac_f32 v208, v169, v216
  v_fmac_f32 v209, v169, v217
  v_fmac_f32 v210, v169, v218
  v_fmac_f32 v211, v169, v219
  v_fmac_f32 v212, v169, v220
  v_fmac_f32 v213, v169, v221
  v_fmac_f32 v214, v169, v222
  v_fmac_f32 v215, v169, v223
  v_permlane32_swap_b32 v208, v212
  v_permlane32_swap_b32 v209, v213
  v_permlane32_swap_b32 v210, v214
  v_permlane32_swap_b32 v211, v215
  v_add_f32 v208, v208, v212
  v_add_f32 v209, v209, v213
  v_add_f32 v210, v210, v214
  v_add_f32 v211, v211, v215
  s_nop 0
  v_permlane16_swap_b32 v208, v210
  v_permlane16_swap_b32 v209, v211
  v_add_f32 v208, v208, v210
  v_add_f32 v209, v209, v211
  s_nop 0
  v_add_f32_dpp v208, v208, v208 row_ror:8 row_mask:0xf bank_mask:0xf
  v_add_f32_dpp v209, v209, v209 row_ror:8 row_mask:0xf bank_mask:0xf
  s_nop 0
  v_add_f32_dpp v208, v208, v208 row_ror:4 row_mask:0xf bank_mask:0xf
  v_add_f32_dpp v209, v209, v209 row_ror:4 row_mask:0xf bank_mask:0xf
  s_mov_b64 exec, s[6:7]
  ds_write_b64 v25, v[208:209] offset:4608
  s_mov_b64 exec, -1
  s_waitcnt lgkmcnt(0)
  s_barrier
  s_cmp_lg_u32 s3, 0
  s_cbranch_scc1 sequential_preLN__gqa_block_cached__mixer_token_mlp__decode_kernel_s3
  ds_read2st64_b32 v[168:169], v26 offset0:18 offset1:19
  ds_read2st64_b32 v[170:171], v26 offset0:20 offset1:21
  s_waitcnt lgkmcnt(0)
  v_add_f32 v168, v168, v169
  v_add_f32 v170, v170, v171
  v_add_f32 v168, v168, v170
  v_mov_b32 v11, v168
  s_nop 1
  v_permlane32_swap_b32 v168, v11
  v_add_f32 v168, v168, v11
  v_min_u32 v168, -2, v168
  s_mov_b32 exec_hi, 0
  global_store_dword v27, v168, s[46:47] sc1
  s_mov_b64 exec, -1
sequential_preLN__gqa_block_cached__mixer_token_mlp__decode_kernel_s3:
  v_add_u32 v176, 851968, v10
  v_add_u32 v177, 856064, v10
  v_add_u32 v178, 860160, v10
  v_add_u32 v179, 864256, v10
  v_add_u32 v180, 868352, v10
  v_add_u32 v181, 872448, v10
  v_add_u32 v182, 876544, v10
  v_add_u32 v183, 880640, v10
  v_lshlrev_b32 v144, 16, v248
  v_and_b32 v145, 0xffff0000, v248
  v_lshlrev_b32 v148, 16, v250
  v_and_b32 v149, 0xffff0000, v250
  v_lshlrev_b32 v146, 16, v249
  v_and_b32 v147, 0xffff0000, v249
  v_lshlrev_b32 v150, 16, v251
  v_and_b32 v151, 0xffff0000, v251
  v_mov_b32 v152, 0xc0135761
  v_mov_b32 v153, 0xc0135761
  v_mov_b32 v154, 1.0
  v_mov_b32 v155, 1.0
  s_mov_b32 s4, 0xbdd2d3e8
  s_mov_b32 s5, 0xbdd2d3e8
  s_cmp_lt_u32 s3, 6
  s_cbranch_scc1 sequential_preLN__gqa_block_cached__mixer_token_mlp__decode_kernel_w2ok
  v_mov_b32 v253, 0
sequential_preLN__gqa_block_cached__mixer_token_mlp__decode_kernel_w2ok:
  v_lshlrev_b32 v254, 16, v254
  s_mov_b32 s30, 0
  s_mov_b32 s31, 0
  s_mov_b64 s[80:81], -1
  s_mov_b64 s[82:83], -1
  s_mov_b64 s[84:85], -1
  s_mov_b64 s[86:87], -1
  s_mov_b64 s[88:89], -1
  s_mov_b64 s[90:91], -1
  s_mov_b64 s[92:93], -1
  s_mov_b64 s[94:95], -1
sequential_preLN__gqa_block_cached__mixer_token_mlp__decode_kernel_p3:
  s_mov_b64 exec, s[80:81]
  global_load_dword v112, v176, s[46:47] sc1
  global_load_dword v113, v176, s[46:47] offset:2048 sc1
  s_mov_b64 exec, s[82:83]
  global_load_dword v114, v177, s[46:47] sc1
  global_load_dword v115, v177, s[46:47] offset:2048 sc1
  s_mov_b64 exec, s[84:85]
  global_load_dword v116, v178, s[46:47] sc1
  global_load_dword v117, v178, s[46:47] offset:2048 sc1
  s_mov_b64 exec, s[86:87]
  global_load_dword v118, v179, s[46:47] sc1
  global_load_dword v119, v179, s[46:47] offset:2048 sc1
  s_mov_b64 exec, s[88:89]
  global_load_dword v120, v180, s[46:47] sc1
  global_load_dword v121, v180, s[46:47] offset:2048 sc1
  s_mov_b64 exec, s[90:91]
  global_load_dword v122, v181, s[46:47] sc1
  global_load_dword v123, v181, s[46:47] offset:2048 sc1
  s_mov_b64 exec, s[92:93]
  global_load_dword v124, v182, s[46:47] sc1
  global_load_dword v125, v182, s[46:47] offset:2048 sc1
  s_mov_b64 exec, s[94:95]
  global_load_dword v126, v183, s[46:47] sc1
  global_load_dword v127, v183, s[46:47] offset:2048 sc1
  s_mov_b64 exec, -1
  s_add_u32 s30, s30, 1
  s_waitcnt vmcnt(14)
  v_max_u32 v128, v112, v113
  v_cmp_eq_u32 s[80:81], -1, v128
  s_waitcnt vmcnt(12)
  v_max_u32 v129, v114, v115
  v_cmp_eq_u32 s[82:83], -1, v129
  s_or_b64 s[34:35], s[80:81], s[82:83]
  s_waitcnt vmcnt(10)
  v_max_u32 v130, v116, v117
  v_cmp_eq_u32 s[84:85], -1, v130
  s_or_b64 s[34:35], s[34:35], s[84:85]
  s_waitcnt vmcnt(8)
  v_max_u32 v131, v118, v119
  v_cmp_eq_u32 s[86:87], -1, v131
  s_or_b64 s[34:35], s[34:35], s[86:87]
  s_waitcnt vmcnt(6)
  v_max_u32 v132, v120, v121
  v_cmp_eq_u32 s[88:89], -1, v132
  s_or_b64 s[34:35], s[34:35], s[88:89]
  s_waitcnt vmcnt(4)
  v_max_u32 v133, v122, v123
  v_cmp_eq_u32 s[90:91], -1, v133
  s_or_b64 s[34:35], s[34:35], s[90:91]
  s_waitcnt vmcnt(2)
  v_max_u32 v134, v124, v125
  v_cmp_eq_u32 s[92:93], -1, v134
  s_or_b64 s[34:35], s[34:35], s[92:93]
  s_waitcnt vmcnt(0)
  v_max_u32 v135, v126, v127
  v_cmp_eq_u32 s[94:95], -1, v135
  s_or_b64 s[34:35], s[34:35], s[94:95]
  s_cbranch_scc0 sequential_preLN__gqa_block_cached__mixer_token_mlp__decode_kernel_p3d
  s_cmp_gt_u32 s30, 400000
  s_cbranch_scc0 sequential_preLN__gqa_block_cached__mixer_token_mlp__decode_kernel_p3
sequential_preLN__gqa_block_cached__mixer_token_mlp__decode_kernel_p3d:
  v_add_f32 v112, v112, v113
  v_add_f32 v114, v114, v115
  v_add_f32 v116, v116, v117
  v_add_f32 v118, v118, v119
  v_add_f32 v120, v120, v121
  v_add_f32 v122, v122, v123
  v_add_f32 v124, v124, v125
  v_add_f32 v126, v126, v127
  v_add_f32 v112, v112, v114
  v_add_f32 v116, v116, v118
  v_add_f32 v120, v120, v122
  v_add_f32 v124, v124, v126
  v_add_f32 v112, v112, v116
  v_add_f32 v120, v120, v124
  v_add_f32 v112, v112, v120
  v_cvt_pk_bf16_f32 v25, v112, v112
  v_lshlrev_b32 v112, 16, v25
  v_add_f32 v112, v112, v254
  v_cvt_pk_bf16_f32 v25, v112, v112
  v_lshlrev_b32 v112, 16, v25
  ds_write_b32 v10, v112 offset:5888
  v_lshlrev_b32 v26, 4, v0
  s_lshl_b32 s29, s2, 3
  v_mov_b32 v25, s29
  s_waitcnt lgkmcnt(0)
  s_barrier
  s_cmp_lg_u32 s3, 0
  s_cbranch_scc1 sequential_preLN__gqa_block_cached__mixer_token_mlp__decode_kernel_lnw
  ds_read_b128 v[216:219], v26 offset:5888
  ds_read_b128 v[220:223], v26 offset:6912
  ds_read_b64 v[234:235], v25 offset:5888
  s_waitcnt lgkmcnt(0)
  v_readfirstlane_b32 s32, v216
  s_mov_b32 s33, s32
  s_nop 0
  v_pk_add_f32 v[176:177], v[216:217], s[32:33] neg_lo:[0,1] neg_hi:[0,1]
  v_pk_add_f32 v[178:179], v[218:219], s[32:33] neg_lo:[0,1] neg_hi:[0,1]
  v_pk_add_f32 v[180:181], v[220:221], s[32:33] neg_lo:[0,1] neg_hi:[0,1]
  v_pk_add_f32 v[182:183], v[222:223], s[32:33] neg_lo:[0,1] neg_hi:[0,1]
  v_pk_mul_f32 v[184:185], v[176:177], v[176:177]
  v_pk_add_f32 v[186:187], v[176:177], v[178:179]
  v_pk_fma_f32 v[184:185], v[178:179], v[178:179], v[184:185]
  v_pk_add_f32 v[176:177], v[180:181], v[182:183]
  v_pk_fma_f32 v[184:185], v[180:181], v[180:181], v[184:185]
  v_pk_add_f32 v[186:187], v[186:187], v[176:177]
  v_pk_fma_f32 v[184:185], v[182:183], v[182:183], v[184:185]
  v_add_f32 v24, v186, v187
  v_add_f32 v25, v184, v185
  s_nop 1
  v_permlane32_swap_b32 v24, v25
  v_add_f32 v24, v24, v25
  s_nop 1
  v_add_f32_dpp v24, v24, v24 quad_perm:[1,0,3,2] row_mask:0xf bank_mask:0xf
  s_nop 1
  v_add_f32_dpp v24, v24, v24 quad_perm:[2,3,0,1] row_mask:0xf bank_mask:0xf
  s_nop 1
  v_add_f32_dpp v24, v24, v24 row_half_mirror row_mask:0xf bank_mask:0xf
  s_nop 1
  v_add_f32_dpp v24, v24, v24 row_mirror row_mask:0xf bank_mask:0xf
  v_mov_b32 v26, v24
  s_nop 1
  v_permlane16_swap_b32 v24, v26
  v_add_f32 v24, v24, v26
  s_nop 0
  v_readlane_b32 s35, v24, 0
  v_readlane_b32 s34, v24, 32
  v_mov_b32 v26, 0x3b000000
  v_mul_f32 v24, s35, v26
  v_mul_f32 v25, s34, v26
  v_add_f32 v27, s32, v24
  v_fma_f32 v25, -v24, v24, v25
  v_max_f32 v25, 0, v25
  v_cvt_pk_bf16_f32 v26, v27, v25
  v_lshlrev_b32 v224, 16, v26
  v_and_b32 v25, 0xffff0000, v26
  v_add_f32 v25, 0x3727c5ac, v25
  v_cvt_pk_bf16_f32 v26, v25, v25
  v_lshlrev_b32 v25, 16, v26
  v_sqrt_f32 v25, v25
  s_nop 0
  v_cvt_pk_bf16_f32 v26, v25, v25
  v_lshlrev_b32 v225, 16, v26
  v_rcp_f32 v226, v225
  v_pk_add_f32 v[112:113], v[216:217], v[224:225] op_sel_hi:[1,0] neg_lo:[0,1] neg_hi:[0,1]
  v_pk_add_f32 v[116:117], v[218:219], v[224:225] op_sel_hi:[1,0] neg_lo:[0,1] neg_hi:[0,1]
  v_pk_add_f32 v[120:121], v[220:221], v[224:225] op_sel_hi:[1,0] neg_lo:[0,1] neg_hi:[0,1]
  v_pk_add_f32 v[124:125], v[222:223], v[224:225] op_sel_hi:[1,0] neg_lo:[0,1] neg_hi:[0,1]
  v_pk_add_f32 v[128:129], v[234:235], v[224:225] op_sel_hi:[1,0] neg_lo:[0,1] neg_hi:[0,1]
  v_cvt_pk_bf16_f32 v114, v112, v113
  v_cvt_pk_bf16_f32 v118, v116, v117
  v_cvt_pk_bf16_f32 v122, v120, v121
  v_cvt_pk_bf16_f32 v126, v124, v125
  v_cvt_pk_bf16_f32 v130, v128, v129
  v_lshlrev_b32 v112, 16, v114
  v_and_b32 v113, 0xffff0000, v114
  v_lshlrev_b32 v116, 16, v118
  v_and_b32 v117, 0xffff0000, v118
  v_lshlrev_b32 v120, 16, v122
  v_and_b32 v121, 0xffff0000, v122
  v_lshlrev_b32 v124, 16, v126
  v_and_b32 v125, 0xffff0000, v126
  v_lshlrev_b32 v128, 16, v130
  v_and_b32 v129, 0xffff0000, v130
  v_pk_mul_f32 v[114:115], v[112:113], v[226:227] op_sel_hi:[1,0]
  v_pk_mul_f32 v[118:119], v[116:117], v[226:227] op_sel_hi:[1,0]
  v_pk_mul_f32 v[122:123], v[120:121], v[226:227] op_sel_hi:[1,0]
  v_pk_mul_f32 v[126:127], v[124:125], v[226:227] op_sel_hi:[1,0]
  v_pk_mul_f32 v[130:131], v[128:129], v[226:227] op_sel_hi:[1,0]
  v_fma_f32 v128, -v130, v225, v128
  v_fma_f32 v129, -v131, v225, v129
  v_cvt_pk_bf16_f32 v112, v114, v115
  v_cvt_pk_bf16_f32 v116, v118, v119
  v_cvt_pk_bf16_f32 v120, v122, v123
  v_cvt_pk_bf16_f32 v124, v126, v127
  v_fmac_f32 v130, v128, v226
  v_fmac_f32 v131, v129, v226
  v_lshlrev_b32 v216, 16, v112
  v_and_b32 v217, 0xffff0000, v112
  v_lshlrev_b32 v218, 16, v116
  v_and_b32 v219, 0xffff0000, v116
  v_lshlrev_b32 v220, 16, v120
  v_and_b32 v221, 0xffff0000, v120
  v_lshlrev_b32 v222, 16, v124
  v_and_b32 v223, 0xffff0000, v124
  v_cvt_pk_bf16_f32 v128, v130, v131
  v_lshlrev_b32 v232, 16, v128
  v_and_b32 v233, 0xffff0000, v128
  v_readfirstlane_b32 s32, v216
  s_mov_b32 s33, s32
  s_nop 0
  v_pk_add_f32 v[176:177], v[216:217], s[32:33] neg_lo:[0,1] neg_hi:[0,1]
  v_pk_add_f32 v[178:179], v[218:219], s[32:33] neg_lo:[0,1] neg_hi:[0,1]
  v_pk_add_f32 v[180:181], v[220:221], s[32:33] neg_lo:[0,1] neg_hi:[0,1]
  v_pk_add_f32 v[182:183], v[222:223], s[32:33] neg_lo:[0,1] neg_hi:[0,1]
  v_pk_mul_f32 v[184:185], v[176:177], v[176:177]
  v_pk_add_f32 v[186:187], v[176:177], v[178:179]
  v_pk_fma_f32 v[184:185], v[178:179], v[178:179], v[184:185]
  v_pk_add_f32 v[176:177], v[180:181], v[182:183]
  v_pk_fma_f32 v[184:185], v[180:181], v[180:181], v[184:185]
  v_pk_add_f32 v[186:187], v[186:187], v[176:177]
  v_pk_fma_f32 v[184:185], v[182:183], v[182:183], v[184:185]
  v_add_f32 v24, v186, v187
  v_add_f32 v25, v184, v185
  s_nop 1
  v_permlane32_swap_b32 v24, v25
  v_add_f32 v24, v24, v25
  s_nop 1
  v_add_f32_dpp v24, v24, v24 quad_perm:[1,0,3,2] row_mask:0xf bank_mask:0xf
  s_nop 1
  v_add_f32_dpp v24, v24, v24 quad_perm:[2,3,0,1] row_mask:0xf bank_mask:0xf
  s_nop 1
  v_add_f32_dpp v24, v24, v24 row_half_mirror row_mask:0xf bank_mask:0xf
  s_nop 1
  v_add_f32_dpp v24, v24, v24 row_mirror row_mask:0xf bank_mask:0xf
  v_mov_b32 v26, v24
  s_nop 1
  v_permlane16_swap_b32 v24, v26
  v_add_f32 v24, v24, v26
  s_nop 0
  v_readlane_b32 s35, v24, 0
  v_readlane_b32 s34, v24, 32
  v_mov_b32 v26, 0x3b000000
  v_mul_f32 v24, s35, v26
  v_mul_f32 v25, s34, v26
  v_add_f32 v27, s32, v24
  v_fma_f32 v25, -v24, v24, v25
  v_max_f32 v25, 0, v25
  v_cvt_pk_bf16_f32 v26, v27, v25
  v_lshlrev_b32 v224, 16, v26
  v_and_b32 v25, 0xffff0000, v26
  v_add_f32 v25, 0x3727c5ac, v25
  v_cvt_pk_bf16_f32 v26, v25, v25
  v_lshlrev_b32 v25, 16, v26
  v_sqrt_f32 v25, v25
  s_nop 0
  v_cvt_pk_bf16_f32 v26, v25, v25
  v_lshlrev_b32 v225, 16, v26
  v_rcp_f32 v226, v225
  v_sub_f32 v24, v232, v224
  v_sub_f32 v25, v233, v224
  v_cvt_pk_bf16_f32 v26, v24, v25
  v_lshlrev_b32 v24, 16, v26
  v_and_b32 v25, 0xffff0000, v26
  v_mul_f32 v26, v24, v226
  v_mul_f32 v27, v25, v226
  v_fma_f32 v24, -v26, v225, v24
  v_fma_f32 v25, -v27, v225, v25
  v_fmac_f32 v26, v24, v226
  v_fmac_f32 v27, v25, v226
  v_cvt_pk_bf16_f32 v228, v26, v27
  v_mov_b32 v24, 0
  ds_write_b32 v24, v228 offset:2048
  s_waitcnt lgkmcnt(0)
sequential_preLN__gqa_block_cached__mixer_token_mlp__decode_kernel_lnw:
  v_mov_b32 v24, 0
  s_barrier
  ds_read_b32 v228, v24 offset:2048
  s_waitcnt lgkmcnt(0)
  v_lshlrev_b32 v232, 16, v228
  v_and_b32 v233, 0xffff0000, v228
  v_pk_mul_f32 v[156:157], v[144:145], v[232:233] op_sel:[0,0] op_sel_hi:[1,0]
  v_pk_mul_f32 v[158:159], v[144:145], v[232:233] op_sel:[0,1] op_sel_hi:[1,1]
  v_pk_mul_f32 v[160:161], v[146:147], v[232:233] op_sel:[0,0] op_sel_hi:[1,0]
  v_pk_mul_f32 v[162:163], v[146:147], v[232:233] op_sel:[0,1] op_sel_hi:[1,1]
  v_cvt_pk_bf16_f32 v112, v156, v157
  v_cvt_pk_bf16_f32 v113, v158, v159
  v_cvt_pk_bf16_f32 v114, v160, v161
  v_cvt_pk_bf16_f32 v115, v162, v163
  v_lshlrev_b32 v156, 16, v112
  v_and_b32 v157, 0xffff0000, v112
  v_lshlrev_b32 v158, 16, v113
  v_and_b32 v159, 0xffff0000, v113
  v_lshlrev_b32 v160, 16, v114
  v_and_b32 v161, 0xffff0000, v114
  v_lshlrev_b32 v162, 16, v115
  v_and_b32 v163, 0xffff0000, v115
  v_pk_add_f32 v[156:157], v[156:157], v[148:149]
  v_pk_add_f32 v[158:159], v[158:159], v[148:149]
  v_pk_add_f32 v[160:161], v[160:161], v[150:151]
  v_pk_add_f32 v[162:163], v[162:163], v[150:151]
  v_cvt_pk_bf16_f32 v112, v156, v157
  v_cvt_pk_bf16_f32 v113, v158, v159
  v_cvt_pk_bf16_f32 v114, v160, v161
  v_cvt_pk_bf16_f32 v115, v162, v163
  v_lshlrev_b32 v156, 16, v112
  v_and_b32 v157, 0xffff0000, v112
  v_lshlrev_b32 v158, 16, v113
  v_and_b32 v159, 0xffff0000, v113
  v_lshlrev_b32 v160, 16, v114
  v_and_b32 v161, 0xffff0000, v114
  v_lshlrev_b32 v162, 16, v115
  v_and_b32 v163, 0xffff0000, v115
  v_pk_mul_f32 v[164:165], v[156:157], v[156:157]
  v_pk_mul_f32 v[166:167], v[158:159], v[158:159]
  v_pk_mul_f32 v[168:169], v[160:161], v[160:161]
  v_pk_mul_f32 v[170:171], v[162:163], v[162:163]
  v_pk_fma_f32 v[164:165], v[164:165], s[4:5], v[152:153]
  v_pk_fma_f32 v[166:167], v[166:167], s[4:5], v[152:153]
  v_pk_fma_f32 v[168:169], v[168:169], s[4:5], v[152:153]
  v_pk_fma_f32 v[170:171], v[170:171], s[4:5], v[152:153]
  v_pk_mul_f32 v[164:165], v[164:165], v[156:157]
  v_pk_mul_f32 v[166:167], v[166:167], v[158:159]
  v_pk_mul_f32 v[168:169], v[168:169], v[160:161]
  v_pk_mul_f32 v[170:171], v[170:171], v[162:163]
  v_exp_f32 v164, v164
  v_exp_f32 v165, v165
  v_exp_f32 v166, v166
  v_exp_f32 v167, v167
  v_exp_f32 v168, v168
  v_exp_f32 v169, v169
  v_exp_f32 v170, v170
  v_exp_f32 v171, v171
  v_pk_add_f32 v[164:165], v[164:165], v[154:155]
  v_pk_add_f32 v[166:167], v[166:167], v[154:155]
  v_pk_add_f32 v[168:169], v[168:169], v[154:155]
  v_pk_add_f32 v[170:171], v[170:171], v[154:155]
  v_rcp_f32 v164, v164
  v_rcp_f32 v165, v165
  v_rcp_f32 v166, v166
  v_rcp_f32 v167, v167
  v_rcp_f32 v168, v168
  v_rcp_f32 v169, v169
  v_rcp_f32 v170, v170
  v_rcp_f32 v171, v171
  v_pk_mul_f32 v[156:157], v[156:157], v[164:165]
  v_pk_mul_f32 v[158:159], v[158:159], v[166:167]
  v_pk_mul_f32 v[160:161], v[160:161], v[168:169]
  v_pk_mul_f32 v[162:163], v[162:163], v[170:171]
  v_cvt_pk_bf16_f32 v112, v156, v157
  v_cvt_pk_bf16_f32 v113, v158, v159
  v_cvt_pk_bf16_f32 v114, v160, v161
  v_cvt_pk_bf16_f32 v115, v162, v163
  v_dot2_f32_bf16 v172, v112, v252, 0
  v_dot2_f32_bf16 v173, v113, v252, 0
  v_dot2_f32_bf16 v172, v114, v253, v172
  v_dot2_f32_bf16 v173, v115, v253, v173
  s_nop 2
  v_permlane32_swap_b32 v172, v173
  v_add_f32 v172, v172, v173
  s_nop 1
  v_add_f32_dpp v172, v172, v172 quad_perm:[1,0,3,2] row_mask:0xf bank_mask:0xf
  s_nop 1
  v_add_f32_dpp v172, v172, v172 quad_perm:[2,3,0,1] row_mask:0xf bank_mask:0xf
  s_nop 1
  v_add_f32_dpp v172, v172, v172 row_half_mirror row_mask:0xf bank_mask:0xf
  s_nop 1
  v_add_f32_dpp v172, v172, v172 row_mirror row_mask:0xf bank_mask:0xf
  v_mov_b32 v24, v172
  s_nop 1
  v_permlane16_swap_b32 v172, v24
  v_add_f32 v172, v172, v24
  s_lshl_b32 s29, s3, 2
  v_add_u32 v24, s29, v0
  s_mov_b32 s6, 1
  s_mov_b32 s7, 1
  v_and_b32 v25, 32, v0
  s_mov_b64 exec, s[6:7]
  ds_write_b32 v24, v172 offset:5632
  s_mov_b64 exec, -1
  v_cmp_ne_u32 vcc, 0, v25
  s_nop 1
  v_cndmask_b32 v234, v234, v235, vcc
  v_lshrrev_b32 v26, 4, v25
  s_lshl_b32 s29, s2, 2
  v_add_u32 v26, s29, v26
  s_waitcnt lgkmcnt(0)
  s_barrier
  s_cmp_lg_u32 s3, 0
  s_cbranch_scc1 sequential_preLN__gqa_block_cached__mixer_token_mlp__decode_kernel_fin
  ds_read_b128 v[156:159], v25 offset:5632
  ds_read_b128 v[160:163], v25 offset:5648
  v_mov_b32 v24, 0
  v_mov_b32 v25, s61
  s_waitcnt lgkmcnt(0)
  v_add_f32 v156, v156, v160
  v_add_f32 v157, v157, v161
  v_add_f32 v158, v158, v162
  v_add_f32 v159, v159, v163
  v_add_f32 v156, v156, v157
  v_add_f32 v158, v158, v159
  v_add_f32 v172, v156, v158
  v_cvt_pk_bf16_f32 v27, v172, v172
  v_lshlrev_b32 v172, 16, v27
  v_add_f32 v172, s60, v172
  v_cvt_pk_bf16_f32 v27, v172, v172
  v_lshlrev_b32 v172, 16, v27
  v_add_f32 v172, v172, v234
  v_cvt_pk_bf16_f32 v172, v172, v172
  s_mov_b64 exec, s[6:7]
  global_store_short v26, v172, s[50:51]
  s_cmp_lg_u32 s2, 0
  s_cbranch_scc1 sequential_preLN__gqa_block_cached__mixer_token_mlp__decode_kernel_fin
  s_mov_b64 exec, 1
  global_store_dword v24, v25, s[46:47] offset:0
sequential_preLN__gqa_block_cached__mixer_token_mlp__decode_kernel_fin:
sequential_preLN__gqa_block_cached__mixer_token_mlp__decode_kernel_end:
  s_endpgm
sequential_preLN__gqa_block_cached__mixer_token_mlp__decode_kernel_w0:
  s_setprio 3
  v_lshrrev_b32 v76, 2, v0
  v_and_b32 v77, 3, v0
  v_lshlrev_b32 v78, 6, v76
  v_lshl_add_u32 v78, v77, 3, v78
  v_lshlrev_b32 v252, 13, v76
  v_lshl_add_u32 v252, v77, 4, v252
  s_and_b32 s31, s21, 1
  s_lshr_b32 s34, s21, 1
  s_lshl_b32 s32, s20, 10
  s_xor_b32 s33, s34, 0
  s_lshl_b32 s33, s33, 6
  s_add_u32 s32, s32, s33
  s_lshl_b32 s33, s31, 21
  s_add_u32 s32, s32, s33
  s_mov_b32 s18, 0x400000
  s_mov_b32 s19, 0x20000
  s_waitcnt lgkmcnt(0)
  global_load_dwordx2 v[248:249], v78, s[36:37]
  global_load_dwordx2 v[250:251], v78, s[36:37] offset:32
  s_mov_b32 s16, s42
  s_mov_b32 s17, s43
  buffer_load_dwordx4 v[176:179], v252, s[16:19], s32 offen nt
  s_add_u32 s32, s32, 0x20000
  buffer_load_dwordx4 v[180:183], v252, s[16:19], s32 offen nt
  s_add_u32 s32, s32, 0x20000
  buffer_load_dwordx4 v[184:187], v252, s[16:19], s32 offen nt
  s_add_u32 s32, s32, 0x20000
  buffer_load_dwordx4 v[188:191], v252, s[16:19], s32 offen nt
  s_add_u32 s32, s32, 0x20000
  buffer_load_dwordx4 v[192:195], v252, s[16:19], s32 offen nt
  s_add_u32 s32, s32, 0x20000
  buffer_load_dwordx4 v[196:199], v252, s[16:19], s32 offen nt
  s_add_u32 s32, s32, 0x20000
  buffer_load_dwordx4 v[200:203], v252, s[16:19], s32 offen nt
  s_add_u32 s32, s32, 0x20000
  buffer_load_dwordx4 v[204:207], v252, s[16:19], s32 offen nt
  s_add_u32 s32, s32, 0x20000
  buffer_load_dwordx4 v[208:211], v252, s[16:19], s32 offen nt
  s_add_u32 s32, s32, 0x20000
  buffer_load_dwordx4 v[212:215], v252, s[16:19], s32 offen nt
  s_add_u32 s32, s32, 0x20000
  buffer_load_dwordx4 v[216:219], v252, s[16:19], s32 offen nt
  s_add_u32 s32, s32, 0x20000
  buffer_load_dwordx4 v[220:223], v252, s[16:19], s32 offen nt
  s_add_u32 s32, s32, 0x20000
  buffer_load_dwordx4 v[224:227], v252, s[16:19], s32 offen nt
  s_add_u32 s32, s32, 0x20000
  buffer_load_dwordx4 v[228:231], v252, s[16:19], s32 offen nt
  s_add_u32 s32, s32, 0x20000
  buffer_load_dwordx4 v[232:235], v252, s[16:19], s32 offen nt
  s_add_u32 s32, s32, 0x20000
  buffer_load_dwordx4 v[236:239], v252, s[16:19], s32 offen nt
  v_mov_b32 v44, -1
  v_mov_b32 v45, -1
  v_mov_b32 v46, -1
  v_mov_b32 v47, -1
  s_lshl_b32 s29, s20, 16
  s_lshl_b32 s30, s21, 10
  s_add_u32 s29, s29, s30
  s_add_u32 s29, s29, 262144
  v_lshl_add_u32 v48, v0, 4, s29
  v_add_u32 v49, 0x8000, v48
  s_lshl_b32 s29, s20, 10
  s_lshl_b32 s30, s21, 3
  s_add_u32 s29, s29, s30
  s_add_u32 s29, s29, 786432
  v_lshl_add_u32 v50, v0, 8, s29
  s_lshl_b32 s29, s20, 12
  s_lshl_b32 s30, s31, 11
  s_add_u32 s29, s29, s30
  s_lshl_b32 s30, s34, 7
  s_add_u32 s29, s29, s30
  s_add_u32 s29, s29, 851968
  v_lshl_add_u32 v51, v0, 4, s29
  global_store_dwordx4 v48, v[44:47], s[46:47] sc1
  global_store_dwordx4 v49, v[44:47], s[46:47] sc1
  s_mov_b64 exec, 0xf
  global_store_dwordx2 v50, v[44:45], s[46:47] sc1
  s_mov_b64 exec, 0xff
  global_store_dwordx4 v51, v[44:47], s[46:47] sc1
  s_mov_b64 exec, -1
  s_mov_b32 s22, 0
  s_lshl_b32 s29, s3, 13
  v_and_b32 v1, 3, v0
  v_lshlrev_b32 v1, 10, v1
  v_bfe_u32 v11, v0, 2, 2
  v_lshl_add_u32 v1, v11, 8, v1
  v_lshrrev_b32 v11, 4, v0
  v_lshl_add_u32 v1, v11, 4, v1
  v_add_u32 v1, s29, v1
  v_add_u32 v2, 0x1000, v1
  v_lshlrev_b32 v3, 4, v0
  v_add_u32 v3, s29, v3
  v_add_u32 v4, 0x1000, v3
  s_lshl_b32 s29, s20, 24
  s_xor_b32 s30, s21, 0
  s_lshl_b32 s30, s30, 19
  s_add_u32 s29, s29, s30
  s_mov_b32 s10, 0x80000
  s_mov_b32 s11, 0x20000
  s_mov_b32 s14, 0x80000
  s_mov_b32 s15, 0x20000
  s_waitcnt lgkmcnt(0)
  s_add_u32 s8, s38, s29
  s_addc_u32 s9, s39, 0
  s_add_u32 s12, s40, s29
  s_addc_u32 s13, s41, 0
  buffer_load_dwordx4 v[112:115], v1, s[8:11], 0 offen offset:0 nt
  buffer_load_dwordx4 v[116:119], v1, s[8:11], 0 offen offset:64 nt
  buffer_load_dwordx4 v[120:123], v1, s[8:11], 0 offen offset:128 nt
  buffer_load_dwordx4 v[124:127], v1, s[8:11], 0 offen offset:192 nt
  buffer_load_dwordx4 v[128:131], v2, s[8:11], 0 offen offset:0 nt
  buffer_load_dwordx4 v[132:135], v2, s[8:11], 0 offen offset:64 nt
  buffer_load_dwordx4 v[136:139], v2, s[8:11], 0 offen offset:128 nt
  buffer_load_dwordx4 v[140:143], v2, s[8:11], 0 offen offset:192 nt
  v_add_u32 v1, s22, v1
  v_add_u32 v2, s22, v2
  buffer_load_dwordx4 v[144:147], v3, s[12:15], 0 offen offset:0 nt
  buffer_load_dwordx4 v[148:151], v3, s[12:15], 0 offen offset:1024 nt
  buffer_load_dwordx4 v[152:155], v3, s[12:15], 0 offen offset:2048 nt
  buffer_load_dwordx4 v[156:159], v3, s[12:15], 0 offen offset:3072 nt
  buffer_load_dwordx4 v[160:163], v4, s[12:15], 0 offen offset:0 nt
  buffer_load_dwordx4 v[164:167], v4, s[12:15], 0 offen offset:1024 nt
  buffer_load_dwordx4 v[168:171], v4, s[12:15], 0 offen offset:2048 nt
  buffer_load_dwordx4 v[172:175], v4, s[12:15], 0 offen offset:3072 nt
  v_add_u32 v3, s22, v3
  v_add_u32 v4, s22, v4
  s_barrier
  s_load_dwordx2 s[48:49], s[0:1], 32
  s_load_dwordx8 s[52:59], s[0:1], 48
  s_load_dwordx2 s[50:51], s[0:1], 80
  s_load_dword s61, s[46:47], 0
  s_getreg_b32 s63, hwreg(HW_REG_XCC_ID, 0, 4)
  s_mov_b32 s25, 0x05040100
  s_mov_b32 s26, 0x07060302
  s_mov_b32 s27, 0x3fb8aa3b
  s_mov_b32 s28, 0x3db504f3
  v_lshrrev_b32 v78, 3, v76
  v_lshlrev_b32 v252, 9, v78
  v_lshl_add_u32 v252, v77, 7, v252
  v_and_b32 v78, 7, v76
  v_lshl_add_u32 v252, v78, 2, v252
  s_lshl_b32 s29, s31, 9
  v_lshl_add_u32 v52, v76, 5, s29
  v_lshrrev_b32 v78, 4, v0
  v_lshlrev_b32 v53, 6, v77
  v_lshl_add_u32 v53, v78, 4, v53
  s_lshl_b32 s29, s20, 13
  s_add_u32 s29, s29, 65536
  s_lshl_b32 s30, s31, 12
  s_add_u32 s30, s30, s29
  s_lshl_b32 s33, s34, 8
  s_add_u32 s30, s30, s33
  v_add_u32 v53, s30, v53
  v_lshl_add_u32 v54, v0, 4, s29
  v_add_u32 v55, 0x1000, v54
  s_lshl_b32 s30, s20, 8
  v_and_b32 v78, 31, v0
  v_lshl_add_u32 v56, v78, 3, s30
  s_lshl_b32 s33, s21, 3
  s_add_u32 s33, s33, s30
  v_mov_b32 v57, s33
  s_waitcnt vmcnt(36)
  v_lshlrev_b32 v240, 16, v248
  v_and_b32 v241, 0xffff0000, v248
  v_lshlrev_b32 v242, 16, v249
  v_and_b32 v243, 0xffff0000, v249
  v_lshlrev_b32 v244, 16, v250
  v_and_b32 v245, 0xffff0000, v250
  v_lshlrev_b32 v246, 16, v251
  v_and_b32 v247, 0xffff0000, v251
  v_add_f32 v76, v240, v241
  v_add_f32 v77, v242, v243
  v_add_f32 v78, v244, v245
  v_add_f32 v76, v76, v77
  v_add_f32 v77, v246, v247
  v_add_f32 v78, v78, v77
  v_add_f32 v76, v76, v78
  s_nop 1
  v_add_f32_dpp v76, v76, v76 quad_perm:[1,0,3,2] row_mask:0xf bank_mask:0xf
  s_nop 1
  v_add_f32_dpp v76, v76, v76 quad_perm:[2,3,0,1] row_mask:0xf bank_mask:0xf
  s_nop 1
  v_add_f32_dpp v76, v76, v76 row_half_mirror row_mask:0xf bank_mask:0xf
  s_nop 1
  v_add_f32_dpp v76, v76, v76 row_mirror row_mask:0xf bank_mask:0xf
  v_mov_b32 v77, v76
  s_nop 1
  v_permlane16_swap_b32 v76, v77
  v_add_f32 v76, v76, v77
  v_mov_b32 v77, v76
  s_nop 1
  v_permlane32_swap_b32 v76, v77
  v_add_f32 v76, v76, v77
  v_mul_f32 v76, 0x3b000000, v76
  v_cvt_pk_bf16_f32 v77, v76, v76
  v_lshlrev_b32 v253, 16, v77
  v_sub_f32 v77, v240, v76
  v_mul_f32 v78, v77, v77
  v_sub_f32 v77, v241, v76
  v_fmac_f32 v78, v77, v77
  v_sub_f32 v77, v242, v76
  v_fmac_f32 v78, v77, v77
  v_sub_f32 v77, v243, v76
  v_fmac_f32 v78, v77, v77
  v_sub_f32 v77, v244, v76
  v_fmac_f32 v78, v77, v77
  v_sub_f32 v77, v245, v76
  v_fmac_f32 v78, v77, v77
  v_sub_f32 v77, v246, v76
  v_fmac_f32 v78, v77, v77
  v_sub_f32 v77, v247, v76
  v_fmac_f32 v78, v77, v77
  s_nop 1
  v_add_f32_dpp v78, v78, v78 quad_perm:[1,0,3,2] row_mask:0xf bank_mask:0xf
  s_nop 1
  v_add_f32_dpp v78, v78, v78 quad_perm:[2,3,0,1] row_mask:0xf bank_mask:0xf
  s_nop 1
  v_add_f32_dpp v78, v78, v78 row_half_mirror row_mask:0xf bank_mask:0xf
  s_nop 1
  v_add_f32_dpp v78, v78, v78 row_mirror row_mask:0xf bank_mask:0xf
  v_mov_b32 v77, v78
  s_nop 1
  v_permlane16_swap_b32 v78, v77
  v_add_f32 v78, v78, v77
  v_mov_b32 v77, v78
  s_nop 1
  v_permlane32_swap_b32 v78, v77
  v_add_f32 v78, v78, v77
  v_mul_f32 v78, 0x3b000000, v78
  v_cvt_pk_bf16_f32 v77, v78, v78
  v_lshlrev_b32 v78, 16, v77
  v_add_f32 v78, 0x3727c5ac, v78
  v_cvt_pk_bf16_f32 v77, v78, v78
  v_lshlrev_b32 v78, 16, v77
  v_sqrt_f32 v78, v78
  s_nop 0
  v_cvt_pk_bf16_f32 v77, v78, v78
  v_lshlrev_b32 v254, 16, v77
  v_rcp_f32 v255, v254
  v_sub_f32 v76, v240, v253
  v_sub_f32 v77, v244, v253
  v_cvt_pk_bf16_f32 v78, v76, v77
  v_lshlrev_b32 v76, 16, v78
  v_and_b32 v77, 0xffff0000, v78
  v_mul_f32 v78, v76, v255
  v_mul_f32 v79, v77, v255
  v_fma_f32 v76, -v78, v254, v76
  v_fma_f32 v77, -v79, v254, v77
  v_fmac_f32 v78, v76, v255
  v_fmac_f32 v79, v77, v255
  v_cvt_pk_bf16_f32 v248, v78, v79
  ds_write_b32 v252, v248 offset:0
  v_sub_f32 v76, v241, v253
  v_sub_f32 v77, v245, v253
  v_cvt_pk_bf16_f32 v78, v76, v77
  v_lshlrev_b32 v76, 16, v78
  v_and_b32 v77, 0xffff0000, v78
  v_mul_f32 v78, v76, v255
  v_mul_f32 v79, v77, v255
  v_fma_f32 v76, -v78, v254, v76
  v_fma_f32 v77, -v79, v254, v77
  v_fmac_f32 v78, v76, v255
  v_fmac_f32 v79, v77, v255
  v_cvt_pk_bf16_f32 v249, v78, v79
  ds_write_b32 v252, v249 offset:32
  v_sub_f32 v76, v242, v253
  v_sub_f32 v77, v246, v253
  v_cvt_pk_bf16_f32 v78, v76, v77
  v_lshlrev_b32 v76, 16, v78
  v_and_b32 v77, 0xffff0000, v78
  v_mul_f32 v78, v76, v255
  v_mul_f32 v79, v77, v255
  v_fma_f32 v76, -v78, v254, v76
  v_fma_f32 v77, -v79, v254, v77
  v_fmac_f32 v78, v76, v255
  v_fmac_f32 v79, v77, v255
  v_cvt_pk_bf16_f32 v250, v78, v79
  ds_write_b32 v252, v250 offset:64
  v_sub_f32 v76, v243, v253
  v_sub_f32 v77, v247, v253
  v_cvt_pk_bf16_f32 v78, v76, v77
  v_lshlrev_b32 v76, 16, v78
  v_and_b32 v77, 0xffff0000, v78
  v_mul_f32 v78, v76, v255
  v_mul_f32 v79, v77, v255
  v_fma_f32 v76, -v78, v254, v76
  v_fma_f32 v77, -v79, v254, v77
  v_fmac_f32 v78, v76, v255
  v_fmac_f32 v79, v77, v255
  v_cvt_pk_bf16_f32 v251, v78, v79
  ds_write_b32 v252, v251 offset:96
  s_waitcnt lgkmcnt(0)
  ds_read_b128 v[240:243], v52 offset:0
  ds_read_b128 v[244:247], v52 offset:16
  v_mov_b32 v60, 0
  v_mov_b32 v61, 0
  v_mov_b32 v62, 0
  v_mov_b32 v63, 0
  v_mov_b32 v64, 0
  v_mov_b32 v65, 0
  v_mov_b32 v66, 0
  v_mov_b32 v67, 0
  s_add_u32 s62, s61, 0x9e3779b9
  v_mov_b32 v69, s62
  v_mov_b32 v71, s62
  v_mov_b32 v72, s63
  v_mov_b32 v73, s62
  s_waitcnt lgkmcnt(0)
  s_waitcnt vmcnt(34)
  v_perm_b32 v76, v180, v176, s25
  v_perm_b32 v77, v180, v176, s26
  v_perm_b32 v78, v181, v177, s25
  v_perm_b32 v79, v181, v177, s26
  v_perm_b32 v80, v182, v178, s25
  v_perm_b32 v81, v182, v178, s26
  v_perm_b32 v82, v183, v179, s25
  v_perm_b32 v83, v183, v179, s26
  v_dot2_f32_bf16 v60, v76, v240, v60
  v_dot2_f32_bf16 v61, v77, v240, v61
  v_dot2_f32_bf16 v62, v78, v240, v62
  v_dot2_f32_bf16 v63, v79, v240, v63
  v_dot2_f32_bf16 v64, v80, v240, v64
  v_dot2_f32_bf16 v65, v81, v240, v65
  v_dot2_f32_bf16 v66, v82, v240, v66
  v_dot2_f32_bf16 v67, v83, v240, v67
  s_waitcnt vmcnt(32)
  v_perm_b32 v76, v188, v184, s25
  v_perm_b32 v77, v188, v184, s26
  v_perm_b32 v78, v189, v185, s25
  v_perm_b32 v79, v189, v185, s26
  v_perm_b32 v80, v190, v186, s25
  v_perm_b32 v81, v190, v186, s26
  v_perm_b32 v82, v191, v187, s25
  v_perm_b32 v83, v191, v187, s26
  v_dot2_f32_bf16 v60, v76, v241, v60
  v_dot2_f32_bf16 v61, v77, v241, v61
  v_dot2_f32_bf16 v62, v78, v241, v62
  v_dot2_f32_bf16 v63, v79, v241, v63
  v_dot2_f32_bf16 v64, v80, v241, v64
  v_dot2_f32_bf16 v65, v81, v241, v65
  v_dot2_f32_bf16 v66, v82, v241, v66
  v_dot2_f32_bf16 v67, v83, v241, v67
  s_waitcnt vmcnt(30)
  v_perm_b32 v76, v196, v192, s25
  v_perm_b32 v77, v196, v192, s26
  v_perm_b32 v78, v197, v193, s25
  v_perm_b32 v79, v197, v193, s26
  v_perm_b32 v80, v198, v194, s25
  v_perm_b32 v81, v198, v194, s26
  v_perm_b32 v82, v199, v195, s25
  v_perm_b32 v83, v199, v195, s26
  v_dot2_f32_bf16 v60, v76, v242, v60
  v_dot2_f32_bf16 v61, v77, v242, v61
  v_dot2_f32_bf16 v62, v78, v242, v62
  v_dot2_f32_bf16 v63, v79, v242, v63
  v_dot2_f32_bf16 v64, v80, v242, v64
  v_dot2_f32_bf16 v65, v81, v242, v65
  v_dot2_f32_bf16 v66, v82, v242, v66
  v_dot2_f32_bf16 v67, v83, v242, v67
  s_waitcnt vmcnt(28)
  v_perm_b32 v76, v204, v200, s25
  v_perm_b32 v77, v204, v200, s26
  v_perm_b32 v78, v205, v201, s25
  v_perm_b32 v79, v205, v201, s26
  v_perm_b32 v80, v206, v202, s25
  v_perm_b32 v81, v206, v202, s26
  v_perm_b32 v82, v207, v203, s25
  v_perm_b32 v83, v207, v203, s26
  v_dot2_f32_bf16 v60, v76, v243, v60
  v_dot2_f32_bf16 v61, v77, v243, v61
  v_dot2_f32_bf16 v62, v78, v243, v62
  v_dot2_f32_bf16 v63, v79, v243, v63
  v_dot2_f32_bf16 v64, v80, v243, v64
  v_dot2_f32_bf16 v65, v81, v243, v65
  v_dot2_f32_bf16 v66, v82, v243, v66
  v_dot2_f32_bf16 v67, v83, v243, v67
  s_waitcnt vmcnt(26)
  v_perm_b32 v76, v212, v208, s25
  v_perm_b32 v77, v212, v208, s26
  v_perm_b32 v78, v213, v209, s25
  v_perm_b32 v79, v213, v209, s26
  v_perm_b32 v80, v214, v210, s25
  v_perm_b32 v81, v214, v210, s26
  v_perm_b32 v82, v215, v211, s25
  v_perm_b32 v83, v215, v211, s26
  v_dot2_f32_bf16 v60, v76, v244, v60
  v_dot2_f32_bf16 v61, v77, v244, v61
  v_dot2_f32_bf16 v62, v78, v244, v62
  v_dot2_f32_bf16 v63, v79, v244, v63
  v_dot2_f32_bf16 v64, v80, v244, v64
  v_dot2_f32_bf16 v65, v81, v244, v65
  v_dot2_f32_bf16 v66, v82, v244, v66
  v_dot2_f32_bf16 v67, v83, v244, v67
  s_waitcnt vmcnt(24)
  v_perm_b32 v76, v220, v216, s25
  v_perm_b32 v77, v220, v216, s26
  v_perm_b32 v78, v221, v217, s25
  v_perm_b32 v79, v221, v217, s26
  v_perm_b32 v80, v222, v218, s25
  v_perm_b32 v81, v222, v218, s26
  v_perm_b32 v82, v223, v219, s25
  v_perm_b32 v83, v223, v219, s26
  v_dot2_f32_bf16 v60, v76, v245, v60
  v_dot2_f32_bf16 v61, v77, v245, v61
  v_dot2_f32_bf16 v62, v78, v245, v62
  v_dot2_f32_bf16 v63, v79, v245, v63
  v_dot2_f32_bf16 v64, v80, v245, v64
  v_dot2_f32_bf16 v65, v81, v245, v65
  v_dot2_f32_bf16 v66, v82, v245, v66
  v_dot2_f32_bf16 v67, v83, v245, v67
  s_waitcnt vmcnt(22)
  v_perm_b32 v76, v228, v224, s25
  v_perm_b32 v77, v228, v224, s26
  v_perm_b32 v78, v229, v225, s25
  v_perm_b32 v79, v229, v225, s26
  v_perm_b32 v80, v230, v226, s25
  v_perm_b32 v81, v230, v226, s26
  v_perm_b32 v82, v231, v227, s25
  v_perm_b32 v83, v231, v227, s26
  v_dot2_f32_bf16 v60, v76, v246, v60
  v_dot2_f32_bf16 v61, v77, v246, v61
  v_dot2_f32_bf16 v62, v78, v246, v62
  v_dot2_f32_bf16 v63, v79, v246, v63
  v_dot2_f32_bf16 v64, v80, v246, v64
  v_dot2_f32_bf16 v65, v81, v246, v65
  v_dot2_f32_bf16 v66, v82, v246, v66
  v_dot2_f32_bf16 v67, v83, v246, v67
  s_waitcnt vmcnt(20)
  v_perm_b32 v76, v236, v232, s25
  v_perm_b32 v77, v236, v232, s26
  v_perm_b32 v78, v237, v233, s25
  v_perm_b32 v79, v237, v233, s26
  v_perm_b32 v80, v238, v234, s25
  v_perm_b32 v81, v238, v234, s26
  v_perm_b32 v82, v239, v235, s25
  v_perm_b32 v83, v239, v235, s26
  v_dot2_f32_bf16 v60, v76, v247, v60
  v_dot2_f32_bf16 v61, v77, v247, v61
  v_dot2_f32_bf16 v62, v78, v247, v62
  v_dot2_f32_bf16 v63, v79, v247, v63
  v_dot2_f32_bf16 v64, v80, v247, v64
  v_dot2_f32_bf16 v65, v81, v247, v65
  v_dot2_f32_bf16 v66, v82, v247, v66
  v_dot2_f32_bf16 v67, v83, v247, v67
  s_nop 2
  v_permlane32_swap_b32 v60, v64
  v_permlane32_swap_b32 v61, v65
  v_permlane32_swap_b32 v62, v66
  v_permlane32_swap_b32 v63, v67
  v_add_f32 v60, v60, v64
  v_add_f32 v61, v61, v65
  v_add_f32 v62, v62, v66
  v_add_f32 v63, v63, v67
  s_nop 0
  v_permlane16_swap_b32 v60, v62
  v_permlane16_swap_b32 v61, v63
  v_add_f32 v60, v60, v62
  v_add_f32 v61, v61, v63
  s_nop 0
  v_add_f32_dpp v60, v60, v60 row_ror:8 row_mask:0xf bank_mask:0xf
  v_add_f32_dpp v61, v61, v61 row_ror:8 row_mask:0xf bank_mask:0xf
  s_nop 0
  v_add_f32_dpp v60, v60, v60 row_ror:4 row_mask:0xf bank_mask:0xf
  v_add_f32_dpp v61, v61, v61 row_ror:4 row_mask:0xf bank_mask:0xf
  v_mov_b32 v68, v60
  v_mov_b32 v70, v61
  s_mov_b32 s4, 0x000f000f
  s_mov_b32 s5, 0x000f000f
  s_waitcnt vmcnt(16)
  s_mov_b64 exec, s[4:5]
  global_store_dwordx4 v53, v[68:71], s[46:47] sc1
  s_mov_b64 exec, 1
  global_store_dwordx2 v57, v[72:73], s[46:47] offset:1024 sc1
  s_mov_b64 exec, -1
  s_mov_b32 s30, 0
  s_mov_b32 s31, 0
sequential_preLN__gqa_block_cached__mixer_token_mlp__decode_kernel_poll:
  s_bitcmp1_b32 s31, 0
  s_cbranch_scc1 sequential_preLN__gqa_block_cached__mixer_token_mlp__decode_kernel_qk0
  global_load_dwordx4 v[176:179], v54, s[46:47] offset:0 sc1
sequential_preLN__gqa_block_cached__mixer_token_mlp__decode_kernel_qk0:
  s_bitcmp1_b32 s31, 1
  s_cbranch_scc1 sequential_preLN__gqa_block_cached__mixer_token_mlp__decode_kernel_qk1
  global_load_dwordx4 v[180:183], v54, s[46:47] offset:1024 sc1
sequential_preLN__gqa_block_cached__mixer_token_mlp__decode_kernel_qk1:
  s_bitcmp1_b32 s31, 2
  s_cbranch_scc1 sequential_preLN__gqa_block_cached__mixer_token_mlp__decode_kernel_qk2
  global_load_dwordx4 v[184:187], v54, s[46:47] offset:2048 sc1
sequential_preLN__gqa_block_cached__mixer_token_mlp__decode_kernel_qk2:
  s_bitcmp1_b32 s31, 3
  s_cbranch_scc1 sequential_preLN__gqa_block_cached__mixer_token_mlp__decode_kernel_qk3
  global_load_dwordx4 v[188:191], v54, s[46:47] offset:3072 sc1
sequential_preLN__gqa_block_cached__mixer_token_mlp__decode_kernel_qk3:
  s_bitcmp1_b32 s31, 4
  s_cbranch_scc1 sequential_preLN__gqa_block_cached__mixer_token_mlp__decode_kernel_qk4
  global_load_dwordx4 v[192:195], v55, s[46:47] offset:0 sc1
sequential_preLN__gqa_block_cached__mixer_token_mlp__decode_kernel_qk4:
  s_bitcmp1_b32 s31, 5
  s_cbranch_scc1 sequential_preLN__gqa_block_cached__mixer_token_mlp__decode_kernel_qk5
  global_load_dwordx4 v[196:199], v55, s[46:47] offset:1024 sc1
sequential_preLN__gqa_block_cached__mixer_token_mlp__decode_kernel_qk5:
  s_bitcmp1_b32 s31, 6
  s_cbranch_scc1 sequential_preLN__gqa_block_cached__mixer_token_mlp__decode_kernel_qk6
  global_load_dwordx4 v[200:203], v55, s[46:47] offset:2048 sc1
sequential_preLN__gqa_block_cached__mixer_token_mlp__decode_kernel_qk6:
  s_bitcmp1_b32 s31, 7
  s_cbranch_scc1 sequential_preLN__gqa_block_cached__mixer_token_mlp__decode_kernel_qk7
  global_load_dwordx4 v[204:207], v55, s[46:47] offset:3072 sc1
sequential_preLN__gqa_block_cached__mixer_token_mlp__decode_kernel_qk7:
  s_add_u32 s30, s30, 1
  s_waitcnt vmcnt(0)
  v_cmp_ne_u32 vcc, s62, v177
  v_cmp_ne_u32 s[4:5], s62, v179
  s_or_b64 vcc, vcc, s[4:5]
  s_cselect_b32 s34, 0, 1
  s_or_b32 s31, s31, s34
  v_cmp_ne_u32 vcc, s62, v181
  v_cmp_ne_u32 s[4:5], s62, v183
  s_or_b64 vcc, vcc, s[4:5]
  s_cselect_b32 s34, 0, 2
  s_or_b32 s31, s31, s34
  v_cmp_ne_u32 vcc, s62, v185
  v_cmp_ne_u32 s[4:5], s62, v187
  s_or_b64 vcc, vcc, s[4:5]
  s_cselect_b32 s34, 0, 4
  s_or_b32 s31, s31, s34
  v_cmp_ne_u32 vcc, s62, v189
  v_cmp_ne_u32 s[4:5], s62, v191
  s_or_b64 vcc, vcc, s[4:5]
  s_cselect_b32 s34, 0, 8
  s_or_b32 s31, s31, s34
  v_cmp_ne_u32 vcc, s62, v193
  v_cmp_ne_u32 s[4:5], s62, v195
  s_or_b64 vcc, vcc, s[4:5]
  s_cselect_b32 s34, 0, 16
  s_or_b32 s31, s31, s34
  v_cmp_ne_u32 vcc, s62, v197
  v_cmp_ne_u32 s[4:5], s62, v199
  s_or_b64 vcc, vcc, s[4:5]
  s_cselect_b32 s34, 0, 32
  s_or_b32 s31, s31, s34
  v_cmp_ne_u32 vcc, s62, v201
  v_cmp_ne_u32 s[4:5], s62, v203
  s_or_b64 vcc, vcc, s[4:5]
  s_cselect_b32 s34, 0, 64
  s_or_b32 s31, s31, s34
  v_cmp_ne_u32 vcc, s62, v205
  v_cmp_ne_u32 s[4:5], s62, v207
  s_or_b64 vcc, vcc, s[4:5]
  s_cselect_b32 s34, 0, 128
  s_or_b32 s31, s31, s34
  s_cmp_gt_u32 s30, 400000
  s_cbranch_scc1 sequential_preLN__gqa_block_cached__mixer_token_mlp__decode_kernel_polled
  s_cmp_eq_u32 s31, 0xff
  s_cbranch_scc0 sequential_preLN__gqa_block_cached__mixer_token_mlp__decode_kernel_poll
sequential_preLN__gqa_block_cached__mixer_token_mlp__decode_kernel_pollx:
  global_load_dwordx2 v[208:209], v56, s[46:47] offset:1024 sc1
  s_add_u32 s30, s30, 1
  s_waitcnt vmcnt(0)
  v_cmp_ne_u32 vcc, s62, v209
  s_cmp_gt_u32 s30, 400000
  s_cbranch_scc1 sequential_preLN__gqa_block_cached__mixer_token_mlp__decode_kernel_polled
  s_cbranch_vccnz sequential_preLN__gqa_block_cached__mixer_token_mlp__decode_kernel_pollx
sequential_preLN__gqa_block_cached__mixer_token_mlp__decode_kernel_polled:
  v_add_f32 v176, v176, v192
  v_add_f32 v178, v178, v194
  v_cvt_pk_bf16_f32 v80, v176, v178
  v_add_f32 v180, v180, v196
  v_add_f32 v182, v182, v198
  v_cvt_pk_bf16_f32 v81, v180, v182
  v_add_f32 v184, v184, v200
  v_add_f32 v186, v186, v202
  v_cvt_pk_bf16_f32 v82, v184, v186
  v_add_f32 v188, v188, v204
  v_add_f32 v190, v190, v206
  v_cvt_pk_bf16_f32 v83, v188, v190
  v_lshlrev_b32 v76, 2, v0
  ds_write2st64_b32 v76, v80, v81 offset0:4 offset1:5
  ds_write2st64_b32 v76, v82, v83 offset0:6 offset1:7
  v_cmp_ne_u32 vcc, s63, v208
  s_cmp_eq_u64 vcc, 0
  s_cselect_b32 s29, 1, 0
  v_mov_b32 v76, 0
  v_mov_b32 v77, s29
  ds_write_b32 v76, v77 offset:2048
  s_waitcnt lgkmcnt(0)
  s_barrier
  s_lshl_b32 s29, s20, 19
  s_and_b32 s30, s21, 1
  s_lshl_b32 s30, s30, 18
  s_add_u32 s29, s29, s30
  s_lshl_b32 s30, s3, 10
  s_add_u32 s29, s29, s30
  s_lshr_b32 s30, s21, 1
  s_lshl_b32 s30, s30, 6
  s_add_u32 s29, s29, s30
  v_lshrrev_b32 v24, 2, v0
  v_lshlrev_b32 v24, 13, v24
  v_and_b32 v25, 3, v0
  v_lshl_add_u32 v24, v25, 4, v24
  v_add_u32 v24, s29, v24
  v_add_u32 v25, 0x20000, v24
  s_waitcnt lgkmcnt(0)
  global_load_dwordx4 v[240:243], v24, s[48:49] nt
  global_load_dwordx4 v[244:247], v25, s[48:49] nt
  s_lshl_b32 s29, s3, 8
  v_lshl_add_u32 v24, v0, 2, s29
  v_add_u32 v25, 2048, v24
  v_min_u32 v25, 3580, v25
  v_lshrrev_b32 v26, 1, v24
  global_load_dword v248, v24, s[52:53]
  global_load_dword v249, v25, s[52:53]
  global_load_dword v250, v24, s[54:55]
  global_load_dword v251, v25, s[54:55]
  global_load_dword v252, v24, s[56:57]
  global_load_dword v253, v25, s[56:57]
  global_load_ushort v254, v26, s[36:37]
  global_load_ushort v255, v26, s[50:51]
  s_setprio 0
  v_mov_b32 v5, 0xff800000
  v_mov_b32 v7, 0
  v_mov_b32 v6, 0
  v_mov_b32 v44, 0
  v_mov_b32 v45, 0
  v_mov_b32 v46, 0
  v_mov_b32 v47, 0
  v_mov_b32 v48, 0
  v_mov_b32 v49, 0
  v_mov_b32 v50, 0
  v_mov_b32 v51, 0
  v_mov_b32 v52, 0
  v_mov_b32 v53, 0
  v_mov_b32 v54, 0
  v_mov_b32 v55, 0
  v_mov_b32 v56, 0
  v_mov_b32 v57, 0
  v_mov_b32 v58, 0
  v_mov_b32 v59, 0
  v_mov_b32 v60, 0
  v_mov_b32 v61, 0
  v_mov_b32 v62, 0
  v_mov_b32 v63, 0
  v_mov_b32 v64, 0
  v_mov_b32 v65, 0
  v_mov_b32 v66, 0
  v_mov_b32 v67, 0
  v_mov_b32 v68, 0
  v_mov_b32 v69, 0
  v_mov_b32 v70, 0
  v_mov_b32 v71, 0
  v_mov_b32 v72, 0
  v_mov_b32 v73, 0
  v_mov_b32 v74, 0
  v_mov_b32 v75, 0
  v_bfe_u32 v11, v0, 2, 2
  v_lshrrev_b32 v10, 4, v0
  v_lshlrev_b32 v11, 8, v11
  v_lshl_add_u32 v11, v10, 4, v11
  s_waitcnt lgkmcnt(0)
  s_load_dword s60, s[58:59], 0
  s_add_u32 s61, s61, 0x9e3779b9
  s_branch sequential_preLN__gqa_block_cached__mixer_token_mlp__decode_kernel_join
sequential_preLN__gqa_block_cached__mixer_token_mlp__decode_kernel_w0wait:
  s_branch sequential_preLN__gqa_block_cached__mixer_token_mlp__decode_kernel_last
sequential_preLN__gqa_block_cached__mixer_token_mlp__decode_kernel_tg0:
  v_lshlrev_b32 v76, 4, v0
  s_mov_b32 s30, 0
sequential_preLN__gqa_block_cached__mixer_token_mlp__decode_kernel_tg:
  global_load_dwordx4 v[176:179], v76, s[46:47] offset:1024 sc1
  global_load_dwordx4 v[180:183], v76, s[46:47] offset:2048 sc1
  s_add_u32 s30, s30, 1
  s_waitcnt vmcnt(0)
  v_xor_b32 v177, s61, v177
  v_xor_b32 v179, s61, v179
  v_xor_b32 v181, s61, v181
  v_xor_b32 v183, s61, v183
  v_or3_b32 v177, v177, v179, v181
  v_or_b32 v177, v177, v183
  v_cmp_ne_u32 vcc, 0, v177
  s_cmp_gt_u32 s30, 400000
  s_cbranch_scc1 sequential_preLN__gqa_block_cached__mixer_token_mlp__decode_kernel_tgd
  s_cbranch_vccnz sequential_preLN__gqa_block_cached__mixer_token_mlp__decode_kernel_tg
  s_branch sequential_preLN__gqa_block_cached__mixer_token_mlp__decode_kernel_tgd
.section .rodata,"a"
.p2align 6
.amdhsa_kernel sequential_preLN__gqa_block_cached__mixer_token_mlp__decode_kernel
  .amdhsa_next_free_vgpr 256
  .amdhsa_next_free_sgpr 96
  .amdhsa_accum_offset 256
  .amdhsa_group_segment_fixed_size 0
  .amdhsa_kernarg_size 104
  .amdhsa_user_sgpr_count 2
  .amdhsa_user_sgpr_kernarg_segment_ptr 1
  .amdhsa_system_sgpr_workgroup_id_x 1
  .amdhsa_float_denorm_mode_32 3
.end_amdhsa_kernel
```
